```python
import torch

def _softmax(x, axis=-1):
    return torch.softmax(x, dim=axis)
def _gelu(x):
    return torch.nn.functional.gelu(x, approximate="tanh")
def _silu(x):
    return torch.nn.functional.silu(x)
def _sigmoid(x):
    return torch.sigmoid(x)
def _layernorm(x, axis=-1, eps=1e-5):
    m = x.mean(dim=axis, keepdim=True)
    v = x.var(dim=axis, keepdim=True, unbiased=False)
    return (x - m) / torch.sqrt(v + eps)
def _scatter_add(tgt, idx, src, axis=0):
    return tgt.clone().index_add_(axis, idx, src)
def _segment_sum(src, seg, n):
    out = torch.zeros((n,) + src.shape[1:], dtype=src.dtype)
    return out.index_add_(0, seg, src)
def _pad(x, pw):
    flat = tuple(v for pair in reversed(pw) for v in pair)
    return torch.nn.functional.pad(x, flat)

kernel_name = 'standalone__fused_io_aware_attn__prompt'

def setup_inputs():

    _w = (lambda a: (lambda t: t.to(torch.bfloat16) if t.is_floating_point() else t)(torch.as_tensor(a)))
    B, H, S = 2, 32, 2048
    Dh = max(1, 640 // 32)
    return {
        "q": _w((lambda *s: torch.randn(*s, dtype=torch.bfloat16) * 0.8)(B, H, S, Dh)),
        "k": _w((lambda *s: torch.randn(*s, dtype=torch.bfloat16) * 0.8)(B, H, S, Dh)),
        "v": _w((lambda *s: torch.randn(*s, dtype=torch.bfloat16) * 0.05)(B, H, S, Dh)),
    }

def reference(q, k, v):
    scale = q.shape[-1] ** -0.5
    s = torch.einsum('bhqd,bhkd->bhqk', q, k) * scale
    p = _softmax(s, axis=-1)
    return torch.einsum('bhqk,bhkd->bhqd', p, v)
```

```asm
; @launch grid=(256,1,1) block=(512,1,1) lds=153600
.amdgcn_target "amdgcn-amd-amdhsa--gfx950"
.text
.globl standalone__fused_io_aware_attn__prompt_kernel
.p2align 8
.type standalone__fused_io_aware_attn__prompt_kernel,@function
standalone__fused_io_aware_attn__prompt_kernel:
    s_load_dwordx8 s[4:11], s[0:1], 0
    s_getpc_b64 s[48:49]
L_pc:
    v_lshlrev_b32 v60, 6, v0
    v_cmp_gt_u32 vcc, 110, v0
    s_and_saveexec_b64 s[44:45], vcc
    s_cbranch_execz L_nocpf
    global_load_dword v61, v60, s[48:49]
L_nocpf:
    s_mov_b64 exec, -1
    s_cmp_ge_u32 s2, 256
    s_cbranch_scc1 L_end
    v_lshrrev_b32 v43, 6, v0
    v_and_b32 v40, 63, v0
    v_readfirstlane_b32 s32, v43
    v_lshlrev_b32 v149, 4, v40
    s_and_b32 s41, s2, 7
    s_lshr_b32 s33, s2, 5
    s_lshl3_add_u32 s33, s41, s33
    s_and_b32 s41, s32, 3
    s_mul_i32 s33, s33, 81920
    s_cmp_lt_u32 s32, 4
    s_cselect_b32 s43, 4, 3
    s_cselect_b32 s36, 0, 4
    s_mul_i32 s43, s43, s41
    s_add_u32 s43, s43, s36
    s_mul_i32 s43, s43, 640
    s_cmp_lt_u32 s32, 4
    s_cselect_b32 s36, 0, 71680
    s_add_u32 m0, s36, s43
    s_add_u32 s43, s43, s33
    s_mul_i32 s41, s41, 640
    s_add_u32 s36, s41, 71680
    s_add_u32 s35, s41, s33
    s_mov_b32 s18, 5242880
    s_mov_b32 s19, 0x20000
    v_and_b32 v42, 31, v0
    v_bfe_u32 v41, v0, 5, 1
    s_bfe_u32 s42, s2, 0x20003
    v_mul_u32_u24 v139, 40, v42
    s_lshl3_add_u32 s42, s42, s32
    v_lshl_add_u32 v137, v41, 4, v139
    s_mul_i32 s34, s42, 2560
    v_mul_u32_u24 v150, 40, v40
    s_add_u32 s34, s34, s33
    s_mov_b32 s14, 5242880
    s_mov_b32 s15, 0x20000
    s_cmp_lt_u32 s32, 4
    s_waitcnt lgkmcnt(0)
    s_mov_b64 s[16:17], s[8:9]
    s_cbranch_scc1 L_ld0
    buffer_load_dwordx4 v149, s[16:19], s43 offen nt lds
    s_mov_b32 exec_hi, 0xffffff
    buffer_load_dwordx4 v149, s[16:19], s43 offen offset:1024 nt lds
    s_mov_b64 exec, -1
    s_mov_b64 s[12:13], s[4:5]
    s_branch L_skipq
L_ld0:
    s_mov_b64 s[12:13], s[6:7]
    buffer_load_dwordx4 v149, s[12:15], s43 offen nt lds
    buffer_load_dwordx4 v149, s[12:15], s43 offen offset:1024 nt lds
    s_mov_b32 exec_hi, 0
    buffer_load_dwordx4 v149, s[12:15], s43 offen offset:2048 nt lds
    s_mov_b32 m0, s36
    s_mov_b32 exec_hi, 0xff
    buffer_load_dwordx4 v149, s[16:19], s35 offen nt lds
    s_mov_b32 exec_hi, -1
    s_mov_b64 s[12:13], s[4:5]
    buffer_load_dwordx4 v[152:155], v137, s[12:15], s34 offen nt
    buffer_load_dwordx4 v[156:159], v137, s[12:15], s34 offen offset:1280 nt
    buffer_load_dwordx2 v[160:161], v150, s[12:15], s34 offen offset:32 nt
L_skipq:
    s_mov_b64 s[24:25], s[6:7]
    s_mov_b64 s[26:27], s[14:15]
    s_mov_b64 s[28:29], s[8:9]
    s_mov_b64 s[30:31], s[14:15]
    s_mov_b64 s[20:21], s[10:11]
    s_mov_b64 s[22:23], s[14:15]
    s_bitcmp0_b32 s32, 1
    s_cselect_b32 s16, s6, s8
    s_cselect_b32 s17, s7, s9
    s_cselect_b32 s36, 0, 71680
    s_and_b32 s41, s32, 1
    s_mul_i32 s41, s41, 5120
    s_add_u32 s36, s36, s41
    s_add_u32 s35, s33, s41
    s_mov_b32 s46, 0x3ea52b5c
    s_mov_b32 s47, 0x3ea52b5c
    s_mov_b32 s39, 0
    v_lshl_add_u32 v162, v41, 3, v139
    v_add_u32 v139, 32, v150
    v_add_u32 v138, 61440, v137
    v_add_u32 v140, 61440, v139
    v_bfe_u32 v43, v40, 2, 2
    v_lshl_add_u32 v43, v41, 3, v43
    v_mul_u32_u24 v43, 40, v43
    v_and_b32 v44, 3, v40
    v_lshl_add_u32 v43, v44, 3, v43
    v_bfe_u32 v45, v40, 4, 1
    v_lshl_add_u32 v43, v45, 5, v43
    v_add_u32 v43, 71680, v43
    v_mul_u32_u24 v45, v44, v45
    v_cmp_eq_u32 vcc, 0, v45
    v_and_b32 v44, 2, v40
    v_lshlrev_b32 v44, 2, v44
    v_add_u32 v141, 143584, v44
    v_mov_b32 v136, 0xdddddddd
    v_cndmask_b32 v141, v141, v43, vcc
    v_cndmask_b32 v148, 0, 1, vcc
    v_mul_u32_u24 v43, 10240, v148
    v_add_u32 v142, v141, v43
    v_add_u32 v143, v142, v43
    v_add_u32 v144, v143, v43
    v_add_u32 v145, v144, v43
    v_add_u32 v146, v145, v43
    v_add_u32 v147, v146, v43
    v_and_b32 v43, 30, v42
    v_and_b32 v44, 1, v42
    v_lshl_add_u32 v43, v43, 1, v44
    v_mul_u32_u24 v43, 160, v43
    v_add_u32 v43, 143584, v43
    v_mov_b32 v48, 0x3f80
    v_mov_b32 v49, 0
    v_mov_b32 v50, 0
    v_mov_b32 v51, 0
    ds_write_b128 v43, v[48:51]
    v_lshlrev_b32 v45, 4, v41
    v_mfma_f32_32x32x4_2b_bf16 v[64:95], v[50:51], v[50:51], 0
    v_mov_b32 v107, 0
    s_cmp_lt_u32 s32, 4
    s_cbranch_scc1 L_pro0
    s_sub_u32 s41, s32, 4
    s_lshl_b32 s41, s41, 13
    s_add_u32 s41, s41, 7040
    v_lshl_add_u32 v60, v40, 7, s41
    v_min_u32 v60, L_last-L_pc, v60
    s_waitcnt lgkmcnt(0)
    s_barrier
    buffer_load_dwordx4 v[152:155], v137, s[12:15], s34 offen nt
    buffer_load_dwordx4 v[156:159], v137, s[12:15], s34 offen offset:1280 nt
    buffer_load_dwordx2 v[160:161], v150, s[12:15], s34 offen offset:32 nt
    ds_read_b64 v[112:113], v139 offset:0
    ds_read_b64 v[108:109], v137 offset:0
    ds_read_b64 v[110:111], v137 offset:8
    ds_read_b64 v[114:115], v137 offset:1280
    ds_read_b64 v[116:117], v137 offset:1288
    s_waitcnt vmcnt(3)
    s_add_u32 m0, s36, 10240
    s_add_u32 s43, s35, 10240
    buffer_load_dwordx4 v149, s[16:19], s43 offen lds
    buffer_load_dwordx4 v149, s[16:19], s43 offen offset:1024 lds
    buffer_load_dwordx4 v149, s[16:19], s43 offen offset:2048 lds
    buffer_load_dwordx4 v149, s[16:19], s43 offen offset:3072 lds
    s_add_u32 m0, s36, 14336
    s_add_u32 s43, s35, 14336
    buffer_load_dwordx4 v149, s[16:19], s43 offen lds
    global_load_dword v151, v60, s[48:49]
    s_barrier
    ds_read_b64_tr_b16 v[120:121], v141 offset:0
    ds_read_b64_tr_b16 v[122:123], v141 offset:160
    ds_read_b64_tr_b16 v[124:125], v141 offset:640
    ds_read_b64_tr_b16 v[126:127], v141 offset:800
    s_waitcnt vmcnt(6)
    s_setprio 3
    v_lshlrev_b32 v48, 16, v160
    v_and_b32 v49, 0xffff0000, v160
    v_lshlrev_b32 v50, 16, v161
    v_and_b32 v51, 0xffff0000, v161
    v_mul_f32 v48, s46, v48
    v_mul_f32 v49, s46, v49
    v_mul_f32 v50, s46, v50
    v_mul_f32 v51, s46, v51
    v_cvt_pk_bf16_f32 v104, v48, v49
    v_cvt_pk_bf16_f32 v105, v50, v51
    s_waitcnt lgkmcnt(0)
    s_nop 0
    v_mfma_f32_32x32x4_2b_bf16 v[0:31], v[112:113], v[104:105], 4.0 cbsz:1 abid:0
    v_lshlrev_b32 v32, 16, v152
    v_and_b32 v33, 0xffff0000, v152
    v_lshlrev_b32 v34, 16, v153
    v_and_b32 v35, 0xffff0000, v153
    v_lshlrev_b32 v36, 16, v154
    v_and_b32 v37, 0xffff0000, v154
    v_lshlrev_b32 v38, 16, v155
    v_and_b32 v39, 0xffff0000, v155
    v_mul_f32 v32, s46, v32
    v_mul_f32 v33, s46, v33
    v_mul_f32 v34, s46, v34
    v_mul_f32 v35, s46, v35
    v_mul_f32 v36, s46, v36
    v_mul_f32 v37, s46, v37
    v_mul_f32 v38, s46, v38
    v_mul_f32 v39, s46, v39
    v_cvt_pk_bf16_f32 v96, v32, v33
    v_cvt_pk_bf16_f32 v97, v34, v35
    v_cvt_pk_bf16_f32 v98, v36, v37
    v_cvt_pk_bf16_f32 v99, v38, v39
    s_nop 1
    v_mfma_f32_32x32x16_bf16 v[0:15], v[108:111], v[96:99], v[0:15]
    v_lshlrev_b32 v40, 16, v156
    v_and_b32 v41, 0xffff0000, v156
    v_lshlrev_b32 v42, 16, v157
    v_and_b32 v43, 0xffff0000, v157
    v_lshlrev_b32 v44, 16, v158
    v_and_b32 v45, 0xffff0000, v158
    v_lshlrev_b32 v46, 16, v159
    v_and_b32 v47, 0xffff0000, v159
    v_mul_f32 v40, s46, v40
    v_mul_f32 v41, s46, v41
    v_mul_f32 v42, s46, v42
    v_mul_f32 v43, s46, v43
    v_mul_f32 v44, s46, v44
    v_mul_f32 v45, s46, v45
    v_mul_f32 v46, s46, v46
    v_mul_f32 v47, s46, v47
    v_cvt_pk_bf16_f32 v100, v40, v41
    v_cvt_pk_bf16_f32 v101, v42, v43
    v_cvt_pk_bf16_f32 v102, v44, v45
    v_cvt_pk_bf16_f32 v103, v46, v47
    s_nop 1
    v_mfma_f32_32x32x16_bf16 v[16:31], v[108:111], v[100:103], v[16:31]
    s_branch L_run1
L_pro0:
    s_waitcnt vmcnt(3) lgkmcnt(0)
    s_barrier
    ds_read_b64 v[112:113], v139 offset:0
    ds_read_b64 v[108:109], v137 offset:0
    ds_read_b64 v[110:111], v137 offset:8
    ds_read_b64 v[114:115], v137 offset:1280
    ds_read_b64 v[116:117], v137 offset:1288
    ds_read_b64_tr_b16 v[120:121], v141 offset:0
    ds_read_b64_tr_b16 v[122:123], v141 offset:160
    ds_read_b64_tr_b16 v[124:125], v141 offset:640
    ds_read_b64_tr_b16 v[126:127], v141 offset:800
    ds_read_b64_tr_b16 v[128:129], v141 offset:1280
    ds_read_b64_tr_b16 v[130:131], v141 offset:1440
    ds_read_b64_tr_b16 v[132:133], v141 offset:1920
    ds_read_b64_tr_b16 v[134:135], v141 offset:2080
    ds_read_b64 v[180:181], v139 offset:2560
    ds_read_b64 v[164:165], v137 offset:2560
    s_waitcnt lgkmcnt(7)
    ds_read_b64 v[166:167], v137 offset:2568
    ds_read_b64 v[168:169], v137 offset:3840
    ds_read_b64 v[170:171], v137 offset:3848
    ds_read_b64 v[182:183], v139 offset:5120
    ds_read_b64 v[172:173], v137 offset:5120
    ds_read_b64 v[174:175], v137 offset:5128
    ds_read_b64 v[176:177], v137 offset:6400
    ds_read_b64 v[178:179], v137 offset:6408
    s_waitcnt vmcnt(0)
    v_lshlrev_b32 v48, 16, v160
    v_and_b32 v49, 0xffff0000, v160
    v_lshlrev_b32 v50, 16, v161
    v_and_b32 v51, 0xffff0000, v161
    v_mul_f32 v48, s46, v48
    v_mul_f32 v49, s46, v49
    v_mul_f32 v50, s46, v50
    v_mul_f32 v51, s46, v51
    v_cvt_pk_bf16_f32 v104, v48, v49
    v_cvt_pk_bf16_f32 v105, v50, v51
    s_waitcnt lgkmcnt(15)
    s_nop 0
    v_mfma_f32_32x32x4_2b_bf16 v[0:31], v[112:113], v[104:105], 4.0 cbsz:1 abid:0
    v_lshlrev_b32 v32, 16, v152
    v_and_b32 v33, 0xffff0000, v152
    v_lshlrev_b32 v34, 16, v153
    v_and_b32 v35, 0xffff0000, v153
    v_lshlrev_b32 v36, 16, v154
    v_and_b32 v37, 0xffff0000, v154
    v_lshlrev_b32 v38, 16, v155
    v_and_b32 v39, 0xffff0000, v155
    v_mul_f32 v32, s46, v32
    v_mul_f32 v33, s46, v33
    v_mul_f32 v34, s46, v34
    v_mul_f32 v35, s46, v35
    v_mul_f32 v36, s46, v36
    v_mul_f32 v37, s46, v37
    v_mul_f32 v38, s46, v38
    v_mul_f32 v39, s46, v39
    v_cvt_pk_bf16_f32 v96, v32, v33
    v_cvt_pk_bf16_f32 v97, v34, v35
    v_cvt_pk_bf16_f32 v98, v36, v37
    v_cvt_pk_bf16_f32 v99, v38, v39
    s_nop 1
    v_mfma_f32_32x32x16_bf16 v[0:15], v[108:111], v[96:99], v[0:15]
    v_lshlrev_b32 v40, 16, v156
    v_and_b32 v41, 0xffff0000, v156
    v_lshlrev_b32 v42, 16, v157
    v_and_b32 v43, 0xffff0000, v157
    v_lshlrev_b32 v44, 16, v158
    v_and_b32 v45, 0xffff0000, v158
    v_lshlrev_b32 v46, 16, v159
    v_and_b32 v47, 0xffff0000, v159
    v_mul_f32 v40, s46, v40
    v_mul_f32 v41, s46, v41
    v_mul_f32 v42, s46, v42
    v_mul_f32 v43, s46, v43
    v_mul_f32 v44, s46, v44
    v_mul_f32 v45, s46, v45
    v_mul_f32 v46, s46, v46
    v_mul_f32 v47, s46, v47
    v_cvt_pk_bf16_f32 v100, v40, v41
    v_cvt_pk_bf16_f32 v101, v42, v43
    v_cvt_pk_bf16_f32 v102, v44, v45
    v_cvt_pk_bf16_f32 v103, v46, v47
    s_nop 1
    v_mfma_f32_32x32x16_bf16 v[16:31], v[108:111], v[100:103], v[16:31]
    v_exp_f32 v0, v0
    v_exp_f32 v1, v1
    s_waitcnt lgkmcnt(0)
    v_exp_f32 v2, v2
    v_exp_f32 v3, v3
    v_exp_f32 v4, v4
    v_exp_f32 v5, v5
    v_mfma_f32_32x32x4_2b_bf16 v[32:63], v[112:113], v[104:105], 4.0 cbsz:1 abid:1
    v_exp_f32 v6, v6
    v_exp_f32 v7, v7
    v_exp_f32 v8, v8
    v_exp_f32 v9, v9
    v_exp_f32 v10, v10
    v_exp_f32 v11, v11
    v_exp_f32 v12, v12
    v_exp_f32 v13, v13
    v_smfmac_f32_32x32x32_bf16 v[64:79], v[120:123], v[0:7], v136
    v_exp_f32 v14, v14
    v_exp_f32 v15, v15
    v_exp_f32 v16, v16
    v_exp_f32 v17, v17
    v_smfmac_f32_32x32x32_bf16 v[64:79], v[124:127], v[8:15], v136
    v_exp_f32 v18, v18
    v_exp_f32 v19, v19
    v_exp_f32 v20, v20
    v_exp_f32 v21, v21
    v_mfma_f32_32x32x16_bf16 v[32:47], v[114:117], v[96:99], v[32:47]
    v_exp_f32 v22, v22
    v_exp_f32 v23, v23
    v_exp_f32 v24, v24
    v_exp_f32 v25, v25
    v_smfmac_f32_32x32x32_bf16 v[80:95], v[120:123], v[16:23], v136
    v_exp_f32 v26, v26
    v_exp_f32 v27, v27
    v_exp_f32 v28, v28
    v_exp_f32 v29, v29
    v_mfma_f32_32x32x16_bf16 v[48:63], v[114:117], v[100:103], v[48:63]
    v_exp_f32 v30, v30
    v_exp_f32 v31, v31
    v_exp_f32 v32, v32
    v_exp_f32 v33, v33
    v_smfmac_f32_32x32x32_bf16 v[80:95], v[124:127], v[24:31], v136
    s_waitcnt lgkmcnt(0)
    v_exp_f32 v34, v34
    v_exp_f32 v35, v35
    v_exp_f32 v36, v36
    v_exp_f32 v37, v37
    v_mfma_f32_32x32x4_2b_bf16 v[0:31], v[180:181], v[104:105], 4.0 cbsz:1 abid:0
    v_exp_f32 v38, v38
    v_exp_f32 v39, v39
    v_exp_f32 v40, v40
    v_exp_f32 v41, v41
    v_exp_f32 v42, v42
    v_exp_f32 v43, v43
    v_exp_f32 v44, v44
    v_exp_f32 v45, v45
    v_smfmac_f32_32x32x32_bf16 v[64:79], v[128:131], v[32:39], v136
    v_exp_f32 v46, v46
    v_exp_f32 v47, v47
    v_exp_f32 v48, v48
    v_exp_f32 v49, v49
    v_smfmac_f32_32x32x32_bf16 v[64:79], v[132:135], v[40:47], v136
    v_exp_f32 v50, v50
    v_exp_f32 v51, v51
    v_exp_f32 v52, v52
    v_exp_f32 v53, v53
    v_mfma_f32_32x32x16_bf16 v[0:15], v[164:167], v[96:99], v[0:15]
    v_exp_f32 v54, v54
    v_exp_f32 v55, v55
    v_exp_f32 v56, v56
    v_exp_f32 v57, v57
    v_smfmac_f32_32x32x32_bf16 v[80:95], v[128:131], v[48:55], v136
    s_barrier
    ds_read_b64_tr_b16 v[120:121], v141 offset:2560
    ds_read_b64_tr_b16 v[122:123], v141 offset:2720
    ds_read_b64_tr_b16 v[124:125], v141 offset:3200
    ds_read_b64_tr_b16 v[126:127], v141 offset:3360
    v_exp_f32 v58, v58
    v_exp_f32 v59, v59
    v_exp_f32 v60, v60
    v_exp_f32 v61, v61
    v_mfma_f32_32x32x16_bf16 v[16:31], v[164:167], v[100:103], v[16:31]
    v_exp_f32 v62, v62
    v_exp_f32 v63, v63
    v_exp_f32 v0, v0
    v_exp_f32 v1, v1
    v_smfmac_f32_32x32x32_bf16 v[80:95], v[132:135], v[56:63], v136
    s_waitcnt lgkmcnt(0)
    v_exp_f32 v2, v2
    v_exp_f32 v3, v3
    v_exp_f32 v4, v4
    v_exp_f32 v5, v5
    v_mfma_f32_32x32x4_2b_bf16 v[32:63], v[180:181], v[104:105], 4.0 cbsz:1 abid:1
    v_exp_f32 v6, v6
    v_exp_f32 v7, v7
    v_exp_f32 v8, v8
    v_exp_f32 v9, v9
    v_exp_f32 v10, v10
    v_exp_f32 v11, v11
    v_exp_f32 v12, v12
    v_exp_f32 v13, v13
    v_smfmac_f32_32x32x32_bf16 v[64:79], v[120:123], v[0:7], v136
    v_exp_f32 v14, v14
    v_exp_f32 v15, v15
    v_exp_f32 v16, v16
    v_exp_f32 v17, v17
    v_smfmac_f32_32x32x32_bf16 v[64:79], v[124:127], v[8:15], v136
    ds_read_b64_tr_b16 v[128:129], v141 offset:3840
    v_exp_f32 v18, v18
    v_exp_f32 v19, v19
    v_exp_f32 v20, v20
    v_exp_f32 v21, v21
    v_mfma_f32_32x32x16_bf16 v[32:47], v[168:171], v[96:99], v[32:47]
    ds_read_b64_tr_b16 v[130:131], v141 offset:4000
    v_exp_f32 v22, v22
    v_exp_f32 v23, v23
    v_exp_f32 v24, v24
    v_exp_f32 v25, v25
    v_smfmac_f32_32x32x32_bf16 v[80:95], v[120:123], v[16:23], v136
    ds_read_b64_tr_b16 v[132:133], v141 offset:4480
    ds_read_b64_tr_b16 v[134:135], v141 offset:4640
    v_exp_f32 v26, v26
    v_exp_f32 v27, v27
    v_exp_f32 v28, v28
    v_exp_f32 v29, v29
    v_mfma_f32_32x32x16_bf16 v[48:63], v[168:171], v[100:103], v[48:63]
    v_exp_f32 v30, v30
    v_exp_f32 v31, v31
    v_exp_f32 v32, v32
    v_exp_f32 v33, v33
    v_smfmac_f32_32x32x32_bf16 v[80:95], v[124:127], v[24:31], v136
    s_waitcnt lgkmcnt(0)
    v_exp_f32 v34, v34
    v_exp_f32 v35, v35
    v_exp_f32 v36, v36
    v_exp_f32 v37, v37
    v_mfma_f32_32x32x4_2b_bf16 v[0:31], v[182:183], v[104:105], 4.0 cbsz:1 abid:0
    v_exp_f32 v38, v38
    v_exp_f32 v39, v39
    v_exp_f32 v40, v40
    v_exp_f32 v41, v41
    v_exp_f32 v42, v42
    v_exp_f32 v43, v43
    v_exp_f32 v44, v44
    v_exp_f32 v45, v45
    v_smfmac_f32_32x32x32_bf16 v[64:79], v[128:131], v[32:39], v136
    v_exp_f32 v46, v46
    v_exp_f32 v47, v47
    v_exp_f32 v48, v48
    v_exp_f32 v49, v49
    v_smfmac_f32_32x32x32_bf16 v[64:79], v[132:135], v[40:47], v136
    ds_read_b64_tr_b16 v[120:121], v141 offset:5120
    v_exp_f32 v50, v50
    v_exp_f32 v51, v51
    v_exp_f32 v52, v52
    v_exp_f32 v53, v53
    v_mfma_f32_32x32x16_bf16 v[0:15], v[172:175], v[96:99], v[0:15]
    ds_read_b64_tr_b16 v[122:123], v141 offset:5280
    v_exp_f32 v54, v54
    v_exp_f32 v55, v55
    v_exp_f32 v56, v56
    v_exp_f32 v57, v57
    v_smfmac_f32_32x32x32_bf16 v[80:95], v[128:131], v[48:55], v136
    ds_read_b64_tr_b16 v[124:125], v141 offset:5760
    ds_read_b64_tr_b16 v[126:127], v141 offset:5920
    v_exp_f32 v58, v58
    v_exp_f32 v59, v59
    v_exp_f32 v60, v60
    v_exp_f32 v61, v61
    v_mfma_f32_32x32x16_bf16 v[16:31], v[172:175], v[100:103], v[16:31]
    v_exp_f32 v62, v62
    v_exp_f32 v63, v63
    v_exp_f32 v0, v0
    v_exp_f32 v1, v1
    v_smfmac_f32_32x32x32_bf16 v[80:95], v[132:135], v[56:63], v136
    v_exp_f32 v2, v2
    v_exp_f32 v3, v3
    v_exp_f32 v4, v4
    v_exp_f32 v5, v5
    v_exp_f32 v6, v6
    v_exp_f32 v7, v7
    v_exp_f32 v8, v8
    v_exp_f32 v9, v9
    v_exp_f32 v10, v10
    v_exp_f32 v11, v11
    v_exp_f32 v12, v12
    v_exp_f32 v13, v13
    v_exp_f32 v14, v14
    v_exp_f32 v15, v15
    v_exp_f32 v16, v16
    s_setprio 2
    v_exp_f32 v17, v17
    v_exp_f32 v18, v18
    v_exp_f32 v19, v19
    v_exp_f32 v20, v20
    v_exp_f32 v21, v21
    v_exp_f32 v22, v22
    v_exp_f32 v23, v23
    v_exp_f32 v24, v24
    v_exp_f32 v25, v25
    v_exp_f32 v26, v26
    v_exp_f32 v27, v27
    v_exp_f32 v28, v28
    v_exp_f32 v29, v29
    v_exp_f32 v30, v30
    v_exp_f32 v31, v31
    s_setprio 3
    s_waitcnt lgkmcnt(0)
    s_barrier
    v_mfma_f32_32x32x4_2b_bf16 v[32:63], v[182:183], v[104:105], 4.0 cbsz:1 abid:1
    ds_read_b64 v[118:119], v139 offset:7680
    ds_read_b64 v[108:109], v137 offset:7680
    ds_read_b64 v[110:111], v137 offset:7688
    v_smfmac_f32_32x32x32_bf16 v[64:79], v[120:123], v[0:7], v136
    ds_read_b64_tr_b16 v[128:129], v141 offset:6400
    ds_read_b64_tr_b16 v[130:131], v141 offset:6560
    s_nop 3
    v_smfmac_f32_32x32x32_bf16 v[64:79], v[124:127], v[8:15], v136
    ds_read_b64_tr_b16 v[132:133], v141 offset:7040
    ds_read_b64_tr_b16 v[134:135], v141 offset:7200
    s_nop 4
    v_mfma_f32_32x32x16_bf16 v[32:47], v[176:179], v[96:99], v[32:47]
    v_mfma_f32_32x32x16_bf16 v[48:63], v[176:179], v[100:103], v[48:63]
    v_smfmac_f32_32x32x32_bf16 v[80:95], v[120:123], v[16:23], v136
    v_smfmac_f32_32x32x32_bf16 v[80:95], v[124:127], v[24:31], v136
    s_nop 7
    s_setprio 0
    v_exp_f32 v32, v32
    v_exp_f32 v33, v33
    v_exp_f32 v34, v34
    v_exp_f32 v35, v35
    v_exp_f32 v36, v36
    v_exp_f32 v37, v37
    v_exp_f32 v38, v38
    v_exp_f32 v39, v39
    v_exp_f32 v40, v40
    v_exp_f32 v41, v41
    v_exp_f32 v42, v42
    v_exp_f32 v43, v43
    v_exp_f32 v44, v44
    v_exp_f32 v45, v45
    v_exp_f32 v46, v46
    v_exp_f32 v47, v47
    v_exp_f32 v48, v48
    s_setprio 2
    v_exp_f32 v49, v49
    v_exp_f32 v50, v50
    v_exp_f32 v51, v51
    v_exp_f32 v52, v52
    v_exp_f32 v53, v53
    v_exp_f32 v54, v54
    v_exp_f32 v55, v55
    v_exp_f32 v56, v56
    v_exp_f32 v57, v57
    v_exp_f32 v58, v58
    v_exp_f32 v59, v59
    v_exp_f32 v60, v60
    v_exp_f32 v61, v61
    v_exp_f32 v62, v62
    v_exp_f32 v63, v63
    s_setprio 3
    s_waitcnt lgkmcnt(0)
    v_mfma_f32_32x32x4_2b_bf16 v[0:31], v[118:119], v[104:105], 4.0 cbsz:1 abid:0
    ds_read_b64 v[114:115], v137 offset:8960
    ds_read_b64 v[116:117], v137 offset:8968
    v_smfmac_f32_32x32x32_bf16 v[64:79], v[128:131], v[32:39], v136
    ds_read_b64_tr_b16 v[120:121], v141 offset:7680
    ds_read_b64_tr_b16 v[122:123], v141 offset:7840
    s_nop 4
    v_smfmac_f32_32x32x32_bf16 v[64:79], v[132:135], v[40:47], v136
    ds_read_b64_tr_b16 v[124:125], v141 offset:8320
    ds_read_b64_tr_b16 v[126:127], v141 offset:8480
    s_nop 4
    v_mfma_f32_32x32x16_bf16 v[0:15], v[108:111], v[96:99], v[0:15]
    v_mfma_f32_32x32x16_bf16 v[16:31], v[108:111], v[100:103], v[16:31]
    v_smfmac_f32_32x32x32_bf16 v[80:95], v[128:131], v[48:55], v136
    v_smfmac_f32_32x32x32_bf16 v[80:95], v[132:135], v[56:63], v136
    s_nop 7
    s_setprio 0
    v_exp_f32 v0, v0
    v_exp_f32 v1, v1
    v_exp_f32 v2, v2
    v_exp_f32 v3, v3
    v_exp_f32 v4, v4
    v_exp_f32 v5, v5
    v_exp_f32 v6, v6
    v_exp_f32 v7, v7
    v_exp_f32 v8, v8
    v_exp_f32 v9, v9
    v_exp_f32 v10, v10
    v_exp_f32 v11, v11
    v_exp_f32 v12, v12
    v_exp_f32 v13, v13
    v_exp_f32 v14, v14
    v_exp_f32 v15, v15
    v_exp_f32 v16, v16
    s_setprio 2
    v_exp_f32 v17, v17
    v_exp_f32 v18, v18
    v_exp_f32 v19, v19
    v_exp_f32 v20, v20
    v_exp_f32 v21, v21
    v_exp_f32 v22, v22
    v_exp_f32 v23, v23
    v_exp_f32 v24, v24
    v_exp_f32 v25, v25
    v_exp_f32 v26, v26
    v_exp_f32 v27, v27
    v_exp_f32 v28, v28
    v_exp_f32 v29, v29
    v_exp_f32 v30, v30
    v_exp_f32 v31, v31
    s_setprio 3
    s_waitcnt vmcnt(0) lgkmcnt(0)
    s_barrier
    v_mfma_f32_32x32x4_2b_bf16 v[32:63], v[118:119], v[104:105], 4.0 cbsz:1 abid:1
    ds_read_b64 v[112:113], v139 offset:10240
    ds_read_b64 v[108:109], v137 offset:10240
    ds_read_b64 v[110:111], v137 offset:10248
    s_add_u32 m0, s36, 20480
    s_add_u32 s43, s35, 20480
    buffer_load_dwordx4 v149, s[16:19], s43 offen lds
    v_smfmac_f32_32x32x32_bf16 v[64:79], v[120:123], v[0:7], v136
    ds_read_b64_tr_b16 v[128:129], v141 offset:8960
    ds_read_b64_tr_b16 v[130:131], v141 offset:9120
    s_nop 2
    v_smfmac_f32_32x32x32_bf16 v[64:79], v[124:127], v[8:15], v136
    ds_read_b64_tr_b16 v[132:133], v141 offset:9600
    ds_read_b64_tr_b16 v[134:135], v141 offset:9760
    s_nop 2
    v_mfma_f32_32x32x16_bf16 v[32:47], v[114:117], v[96:99], v[32:47]
    v_mfma_f32_32x32x16_bf16 v[48:63], v[114:117], v[100:103], v[48:63]
    v_smfmac_f32_32x32x32_bf16 v[80:95], v[120:123], v[16:23], v136
    v_smfmac_f32_32x32x32_bf16 v[80:95], v[124:127], v[24:31], v136
    s_nop 7
    s_setprio 0
    v_exp_f32 v32, v32
    v_exp_f32 v33, v33
    v_exp_f32 v34, v34
    v_exp_f32 v35, v35
    v_exp_f32 v36, v36
    v_exp_f32 v37, v37
    v_exp_f32 v38, v38
    v_exp_f32 v39, v39
    v_exp_f32 v40, v40
    v_exp_f32 v41, v41
    v_exp_f32 v42, v42
    v_exp_f32 v43, v43
    v_exp_f32 v44, v44
    v_exp_f32 v45, v45
    v_exp_f32 v46, v46
    v_exp_f32 v47, v47
    v_exp_f32 v48, v48
    s_setprio 2
    v_exp_f32 v49, v49
    v_exp_f32 v50, v50
    v_exp_f32 v51, v51
    v_exp_f32 v52, v52
    v_exp_f32 v53, v53
    v_exp_f32 v54, v54
    v_exp_f32 v55, v55
    v_exp_f32 v56, v56
    v_exp_f32 v57, v57
    v_exp_f32 v58, v58
    v_exp_f32 v59, v59
    v_exp_f32 v60, v60
    v_exp_f32 v61, v61
    v_exp_f32 v62, v62
    v_exp_f32 v63, v63
    s_setprio 3
    s_waitcnt lgkmcnt(0)
    v_mfma_f32_32x32x4_2b_bf16 v[0:31], v[112:113], v[104:105], 4.0 cbsz:1 abid:0
    ds_read_b64 v[114:115], v137 offset:11520
    ds_read_b64 v[116:117], v137 offset:11528
    buffer_load_dwordx4 v149, s[16:19], s43 offen offset:1024 lds
    v_smfmac_f32_32x32x32_bf16 v[64:79], v[128:131], v[32:39], v136
    ds_read_b64_tr_b16 v[120:121], v142 offset:0
    ds_read_b64_tr_b16 v[122:123], v142 offset:160
    s_nop 3
    v_smfmac_f32_32x32x32_bf16 v[64:79], v[132:135], v[40:47], v136
    ds_read_b64_tr_b16 v[124:125], v142 offset:640
    ds_read_b64_tr_b16 v[126:127], v142 offset:800
    s_nop 4
    v_mfma_f32_32x32x16_bf16 v[0:15], v[108:111], v[96:99], v[0:15]
    v_mfma_f32_32x32x16_bf16 v[16:31], v[108:111], v[100:103], v[16:31]
    v_smfmac_f32_32x32x32_bf16 v[80:95], v[128:131], v[48:55], v136
    v_smfmac_f32_32x32x32_bf16 v[80:95], v[132:135], v[56:63], v136
    s_nop 7
    s_setprio 0
    v_exp_f32 v0, v0
    v_exp_f32 v1, v1
    v_exp_f32 v2, v2
    v_exp_f32 v3, v3
    v_exp_f32 v4, v4
    v_exp_f32 v5, v5
    v_exp_f32 v6, v6
    v_exp_f32 v7, v7
    v_exp_f32 v8, v8
    v_exp_f32 v9, v9
    v_exp_f32 v10, v10
    v_exp_f32 v11, v11
    v_exp_f32 v12, v12
    v_exp_f32 v13, v13
    v_exp_f32 v14, v14
    v_exp_f32 v15, v15
    v_exp_f32 v16, v16
    s_setprio 2
    v_exp_f32 v17, v17
    v_exp_f32 v18, v18
    v_exp_f32 v19, v19
    v_exp_f32 v20, v20
    v_exp_f32 v21, v21
    v_exp_f32 v22, v22
    v_exp_f32 v23, v23
    v_exp_f32 v24, v24
    v_exp_f32 v25, v25
    v_exp_f32 v26, v26
    v_exp_f32 v27, v27
    v_exp_f32 v28, v28
    v_exp_f32 v29, v29
    v_exp_f32 v30, v30
    v_exp_f32 v31, v31
    s_setprio 3
    s_waitcnt lgkmcnt(0)
    v_mfma_f32_32x32x4_2b_bf16 v[32:63], v[112:113], v[104:105], 4.0 cbsz:1 abid:1
    ds_read_b64 v[118:119], v139 offset:12800
    ds_read_b64 v[108:109], v137 offset:12800
    ds_read_b64 v[110:111], v137 offset:12808
    buffer_load_dwordx4 v149, s[16:19], s43 offen offset:2048 lds
    v_smfmac_f32_32x32x32_bf16 v[64:79], v[120:123], v[0:7], v136
    ds_read_b64_tr_b16 v[128:129], v142 offset:1280
    ds_read_b64_tr_b16 v[130:131], v142 offset:1440
    s_nop 3
    v_smfmac_f32_32x32x32_bf16 v[64:79], v[124:127], v[8:15], v136
    ds_read_b64_tr_b16 v[132:133], v142 offset:1920
    ds_read_b64_tr_b16 v[134:135], v142 offset:2080
    s_nop 3
    v_mfma_f32_32x32x16_bf16 v[32:47], v[114:117], v[96:99], v[32:47]
    v_mfma_f32_32x32x16_bf16 v[48:63], v[114:117], v[100:103], v[48:63]
    v_smfmac_f32_32x32x32_bf16 v[80:95], v[120:123], v[16:23], v136
    v_smfmac_f32_32x32x32_bf16 v[80:95], v[124:127], v[24:31], v136
    s_nop 7
    s_setprio 0
    v_exp_f32 v32, v32
    v_exp_f32 v33, v33
    v_exp_f32 v34, v34
    v_exp_f32 v35, v35
    v_exp_f32 v36, v36
    v_exp_f32 v37, v37
    v_exp_f32 v38, v38
    v_exp_f32 v39, v39
    v_exp_f32 v40, v40
    v_exp_f32 v41, v41
    v_exp_f32 v42, v42
    v_exp_f32 v43, v43
    v_exp_f32 v44, v44
    v_exp_f32 v45, v45
    v_exp_f32 v46, v46
    v_exp_f32 v47, v47
    v_exp_f32 v48, v48
    s_setprio 2
    v_exp_f32 v49, v49
    v_exp_f32 v50, v50
    v_exp_f32 v51, v51
    v_exp_f32 v52, v52
    v_exp_f32 v53, v53
    v_exp_f32 v54, v54
    v_exp_f32 v55, v55
    v_exp_f32 v56, v56
    v_exp_f32 v57, v57
    v_exp_f32 v58, v58
    v_exp_f32 v59, v59
    v_exp_f32 v60, v60
    v_exp_f32 v61, v61
    v_exp_f32 v62, v62
    v_exp_f32 v63, v63
    s_setprio 3
    s_waitcnt lgkmcnt(0)
    v_mfma_f32_32x32x4_2b_bf16 v[0:31], v[118:119], v[104:105], 4.0 cbsz:1 abid:0
    ds_read_b64 v[114:115], v137 offset:14080
    ds_read_b64 v[116:117], v137 offset:14088
    buffer_load_dwordx4 v149, s[16:19], s43 offen offset:3072 lds
    v_smfmac_f32_32x32x32_bf16 v[64:79], v[128:131], v[32:39], v136
    ds_read_b64_tr_b16 v[120:121], v142 offset:2560
    ds_read_b64_tr_b16 v[122:123], v142 offset:2720
    s_nop 3
    v_smfmac_f32_32x32x32_bf16 v[64:79], v[132:135], v[40:47], v136
    ds_read_b64_tr_b16 v[124:125], v142 offset:3200
    ds_read_b64_tr_b16 v[126:127], v142 offset:3360
    s_nop 4
    v_mfma_f32_32x32x16_bf16 v[0:15], v[108:111], v[96:99], v[0:15]
    v_mfma_f32_32x32x16_bf16 v[16:31], v[108:111], v[100:103], v[16:31]
    v_smfmac_f32_32x32x32_bf16 v[80:95], v[128:131], v[48:55], v136
    v_smfmac_f32_32x32x32_bf16 v[80:95], v[132:135], v[56:63], v136
    s_nop 7
    s_setprio 0
    v_exp_f32 v0, v0
    v_exp_f32 v1, v1
    v_exp_f32 v2, v2
    v_exp_f32 v3, v3
    v_exp_f32 v4, v4
    v_exp_f32 v5, v5
    v_exp_f32 v6, v6
    v_exp_f32 v7, v7
    v_exp_f32 v8, v8
    v_exp_f32 v9, v9
    v_exp_f32 v10, v10
    v_exp_f32 v11, v11
    v_exp_f32 v12, v12
    v_exp_f32 v13, v13
    v_exp_f32 v14, v14
    v_exp_f32 v15, v15
    v_exp_f32 v16, v16
    s_setprio 2
    v_exp_f32 v17, v17
    v_exp_f32 v18, v18
    v_exp_f32 v19, v19
    v_exp_f32 v20, v20
    v_exp_f32 v21, v21
    v_exp_f32 v22, v22
    v_exp_f32 v23, v23
    v_exp_f32 v24, v24
    v_exp_f32 v25, v25
    v_exp_f32 v26, v26
    v_exp_f32 v27, v27
    v_exp_f32 v28, v28
    v_exp_f32 v29, v29
    v_exp_f32 v30, v30
    v_exp_f32 v31, v31
    s_setprio 3
    s_waitcnt lgkmcnt(0)
    v_mfma_f32_32x32x4_2b_bf16 v[32:63], v[118:119], v[104:105], 4.0 cbsz:1 abid:1
    ds_read_b64 v[112:113], v139 offset:15360
    ds_read_b64 v[108:109], v137 offset:15360
    ds_read_b64 v[110:111], v137 offset:15368
    s_add_u32 m0, s36, 24576
    s_add_u32 s43, s35, 24576
    buffer_load_dwordx4 v149, s[16:19], s43 offen lds
    v_smfmac_f32_32x32x32_bf16 v[64:79], v[120:123], v[0:7], v136
    ds_read_b64_tr_b16 v[128:129], v142 offset:3840
    ds_read_b64_tr_b16 v[130:131], v142 offset:4000
    s_nop 2
    v_smfmac_f32_32x32x32_bf16 v[64:79], v[124:127], v[8:15], v136
    ds_read_b64_tr_b16 v[132:133], v142 offset:4480
    ds_read_b64_tr_b16 v[134:135], v142 offset:4640
    s_nop 2
    v_mfma_f32_32x32x16_bf16 v[32:47], v[114:117], v[96:99], v[32:47]
    v_mfma_f32_32x32x16_bf16 v[48:63], v[114:117], v[100:103], v[48:63]
    v_smfmac_f32_32x32x32_bf16 v[80:95], v[120:123], v[16:23], v136
    v_smfmac_f32_32x32x32_bf16 v[80:95], v[124:127], v[24:31], v136
    s_nop 7
    s_setprio 0
    v_exp_f32 v32, v32
    v_exp_f32 v33, v33
    v_exp_f32 v34, v34
    v_exp_f32 v35, v35
    v_exp_f32 v36, v36
    v_exp_f32 v37, v37
    v_exp_f32 v38, v38
    v_exp_f32 v39, v39
    v_exp_f32 v40, v40
    v_exp_f32 v41, v41
    v_exp_f32 v42, v42
    v_exp_f32 v43, v43
    v_exp_f32 v44, v44
    v_exp_f32 v45, v45
    v_exp_f32 v46, v46
    v_exp_f32 v47, v47
    v_exp_f32 v48, v48
    s_setprio 2
    v_exp_f32 v49, v49
    v_exp_f32 v50, v50
    v_exp_f32 v51, v51
    v_exp_f32 v52, v52
    v_exp_f32 v53, v53
    v_exp_f32 v54, v54
    v_exp_f32 v55, v55
    v_exp_f32 v56, v56
    v_exp_f32 v57, v57
    v_exp_f32 v58, v58
    v_exp_f32 v59, v59
    v_exp_f32 v60, v60
    v_exp_f32 v61, v61
    v_exp_f32 v62, v62
    v_exp_f32 v63, v63
    s_setprio 3
    s_waitcnt lgkmcnt(0)
    v_mfma_f32_32x32x4_2b_bf16 v[0:31], v[112:113], v[104:105], 4.0 cbsz:1 abid:0
    ds_read_b64 v[114:115], v137 offset:16640
    ds_read_b64 v[116:117], v137 offset:16648
    v_smfmac_f32_32x32x32_bf16 v[64:79], v[128:131], v[32:39], v136
    ds_read_b64_tr_b16 v[120:121], v142 offset:5120
    ds_read_b64_tr_b16 v[122:123], v142 offset:5280
    s_nop 4
    v_smfmac_f32_32x32x32_bf16 v[64:79], v[132:135], v[40:47], v136
    ds_read_b64_tr_b16 v[124:125], v142 offset:5760
    ds_read_b64_tr_b16 v[126:127], v142 offset:5920
    s_nop 4
    v_mfma_f32_32x32x16_bf16 v[0:15], v[108:111], v[96:99], v[0:15]
    v_mfma_f32_32x32x16_bf16 v[16:31], v[108:111], v[100:103], v[16:31]
    v_smfmac_f32_32x32x32_bf16 v[80:95], v[128:131], v[48:55], v136
    v_smfmac_f32_32x32x32_bf16 v[80:95], v[132:135], v[56:63], v136
    s_nop 7
    s_setprio 0
    v_exp_f32 v0, v0
    v_exp_f32 v1, v1
    v_exp_f32 v2, v2
    v_exp_f32 v3, v3
    v_exp_f32 v4, v4
    v_exp_f32 v5, v5
    v_exp_f32 v6, v6
    v_exp_f32 v7, v7
    v_exp_f32 v8, v8
    v_exp_f32 v9, v9
    v_exp_f32 v10, v10
    v_exp_f32 v11, v11
    v_exp_f32 v12, v12
    v_exp_f32 v13, v13
    v_exp_f32 v14, v14
    v_exp_f32 v15, v15
    v_exp_f32 v16, v16
    s_setprio 2
    v_exp_f32 v17, v17
    v_exp_f32 v18, v18
    v_exp_f32 v19, v19
    v_exp_f32 v20, v20
    v_exp_f32 v21, v21
    v_exp_f32 v22, v22
    v_exp_f32 v23, v23
    v_exp_f32 v24, v24
    v_exp_f32 v25, v25
    v_exp_f32 v26, v26
    v_exp_f32 v27, v27
    v_exp_f32 v28, v28
    v_exp_f32 v29, v29
    v_exp_f32 v30, v30
    v_exp_f32 v31, v31
    s_setprio 3
    s_waitcnt lgkmcnt(0)
    v_mfma_f32_32x32x4_2b_bf16 v[32:63], v[112:113], v[104:105], 4.0 cbsz:1 abid:1
    ds_read_b64 v[118:119], v139 offset:17920
    ds_read_b64 v[108:109], v137 offset:17920
    ds_read_b64 v[110:111], v137 offset:17928
    v_smfmac_f32_32x32x32_bf16 v[64:79], v[120:123], v[0:7], v136
    ds_read_b64_tr_b16 v[128:129], v142 offset:6400
    ds_read_b64_tr_b16 v[130:131], v142 offset:6560
    s_nop 3
    v_smfmac_f32_32x32x32_bf16 v[64:79], v[124:127], v[8:15], v136
    ds_read_b64_tr_b16 v[132:133], v142 offset:7040
    ds_read_b64_tr_b16 v[134:135], v142 offset:7200
    s_nop 4
    v_mfma_f32_32x32x16_bf16 v[32:47], v[114:117], v[96:99], v[32:47]
    v_mfma_f32_32x32x16_bf16 v[48:63], v[114:117], v[100:103], v[48:63]
    v_smfmac_f32_32x32x32_bf16 v[80:95], v[120:123], v[16:23], v136
    v_smfmac_f32_32x32x32_bf16 v[80:95], v[124:127], v[24:31], v136
    s_nop 7
    s_setprio 0
    v_exp_f32 v32, v32
    v_exp_f32 v33, v33
    v_exp_f32 v34, v34
    v_exp_f32 v35, v35
    v_exp_f32 v36, v36
    v_exp_f32 v37, v37
    v_exp_f32 v38, v38
    v_exp_f32 v39, v39
    v_exp_f32 v40, v40
    v_exp_f32 v41, v41
    v_exp_f32 v42, v42
    v_exp_f32 v43, v43
    v_exp_f32 v44, v44
    v_exp_f32 v45, v45
    v_exp_f32 v46, v46
    v_exp_f32 v47, v47
    v_exp_f32 v48, v48
    s_setprio 2
    v_exp_f32 v49, v49
    v_exp_f32 v50, v50
    v_exp_f32 v51, v51
    v_exp_f32 v52, v52
    v_exp_f32 v53, v53
    v_exp_f32 v54, v54
    v_exp_f32 v55, v55
    v_exp_f32 v56, v56
    v_exp_f32 v57, v57
    v_exp_f32 v58, v58
    v_exp_f32 v59, v59
    v_exp_f32 v60, v60
    v_exp_f32 v61, v61
    v_exp_f32 v62, v62
    v_exp_f32 v63, v63
    s_setprio 3
    s_waitcnt lgkmcnt(0)
    v_mfma_f32_32x32x4_2b_bf16 v[0:31], v[118:119], v[104:105], 4.0 cbsz:1 abid:0
    ds_read_b64 v[114:115], v137 offset:19200
    ds_read_b64 v[116:117], v137 offset:19208
    v_smfmac_f32_32x32x32_bf16 v[64:79], v[128:131], v[32:39], v136
    ds_read_b64_tr_b16 v[120:121], v142 offset:7680
    ds_read_b64_tr_b16 v[122:123], v142 offset:7840
    s_nop 4
    v_smfmac_f32_32x32x32_bf16 v[64:79], v[132:135], v[40:47], v136
    ds_read_b64_tr_b16 v[124:125], v142 offset:8320
    ds_read_b64_tr_b16 v[126:127], v142 offset:8480
    s_nop 4
    v_mfma_f32_32x32x16_bf16 v[0:15], v[108:111], v[96:99], v[0:15]
    v_mfma_f32_32x32x16_bf16 v[16:31], v[108:111], v[100:103], v[16:31]
    v_smfmac_f32_32x32x32_bf16 v[80:95], v[128:131], v[48:55], v136
    v_smfmac_f32_32x32x32_bf16 v[80:95], v[132:135], v[56:63], v136
    s_nop 7
    s_setprio 0
    v_exp_f32 v0, v0
    v_exp_f32 v1, v1
    v_exp_f32 v2, v2
    v_exp_f32 v3, v3
    v_exp_f32 v4, v4
    v_exp_f32 v5, v5
    v_exp_f32 v6, v6
    v_exp_f32 v7, v7
    v_exp_f32 v8, v8
    v_exp_f32 v9, v9
    v_exp_f32 v10, v10
    v_exp_f32 v11, v11
    v_exp_f32 v12, v12
    v_exp_f32 v13, v13
    v_exp_f32 v14, v14
    v_exp_f32 v15, v15
    v_exp_f32 v16, v16
    s_setprio 2
    v_exp_f32 v17, v17
    v_exp_f32 v18, v18
    v_exp_f32 v19, v19
    v_exp_f32 v20, v20
    v_exp_f32 v21, v21
    v_exp_f32 v22, v22
    v_exp_f32 v23, v23
    v_exp_f32 v24, v24
    v_exp_f32 v25, v25
    v_exp_f32 v26, v26
    v_exp_f32 v27, v27
    v_exp_f32 v28, v28
    v_exp_f32 v29, v29
    v_exp_f32 v30, v30
    v_exp_f32 v31, v31
    s_setprio 3
    s_waitcnt vmcnt(0) lgkmcnt(0)
    s_barrier
    v_mfma_f32_32x32x4_2b_bf16 v[32:63], v[118:119], v[104:105], 4.0 cbsz:1 abid:1
    ds_read_b64 v[112:113], v139 offset:20480
    ds_read_b64 v[108:109], v137 offset:20480
    ds_read_b64 v[110:111], v137 offset:20488
    s_add_u32 m0, s36, 40960
    s_add_u32 s43, s35, 40960
    buffer_load_dwordx4 v149, s[16:19], s43 offen lds
    v_smfmac_f32_32x32x32_bf16 v[64:79], v[120:123], v[0:7], v136
    ds_read_b64_tr_b16 v[128:129], v142 offset:8960
    ds_read_b64_tr_b16 v[130:131], v142 offset:9120
    s_nop 2
    v_smfmac_f32_32x32x32_bf16 v[64:79], v[124:127], v[8:15], v136
    ds_read_b64_tr_b16 v[132:133], v142 offset:9600
    ds_read_b64_tr_b16 v[134:135], v142 offset:9760
    s_nop 2
    v_mfma_f32_32x32x16_bf16 v[32:47], v[114:117], v[96:99], v[32:47]
    v_mfma_f32_32x32x16_bf16 v[48:63], v[114:117], v[100:103], v[48:63]
    v_smfmac_f32_32x32x32_bf16 v[80:95], v[120:123], v[16:23], v136
    v_smfmac_f32_32x32x32_bf16 v[80:95], v[124:127], v[24:31], v136
    s_nop 7
    s_setprio 0
    v_exp_f32 v32, v32
    v_exp_f32 v33, v33
    v_exp_f32 v34, v34
    v_exp_f32 v35, v35
    v_exp_f32 v36, v36
    v_exp_f32 v37, v37
    v_exp_f32 v38, v38
    v_exp_f32 v39, v39
    v_exp_f32 v40, v40
    v_exp_f32 v41, v41
    v_exp_f32 v42, v42
    v_exp_f32 v43, v43
    v_exp_f32 v44, v44
    v_exp_f32 v45, v45
    v_exp_f32 v46, v46
    v_exp_f32 v47, v47
    v_exp_f32 v48, v48
    s_setprio 2
    v_exp_f32 v49, v49
    v_exp_f32 v50, v50
    v_exp_f32 v51, v51
    v_exp_f32 v52, v52
    v_exp_f32 v53, v53
    v_exp_f32 v54, v54
    v_exp_f32 v55, v55
    v_exp_f32 v56, v56
    v_exp_f32 v57, v57
    v_exp_f32 v58, v58
    v_exp_f32 v59, v59
    v_exp_f32 v60, v60
    v_exp_f32 v61, v61
    v_exp_f32 v62, v62
    v_exp_f32 v63, v63
    s_setprio 3
    s_waitcnt lgkmcnt(0)
    v_mfma_f32_32x32x4_2b_bf16 v[0:31], v[112:113], v[104:105], 4.0 cbsz:1 abid:0
    ds_read_b64 v[114:115], v137 offset:21760
    ds_read_b64 v[116:117], v137 offset:21768
    buffer_load_dwordx4 v149, s[16:19], s43 offen offset:1024 lds
    v_smfmac_f32_32x32x32_bf16 v[64:79], v[128:131], v[32:39], v136
    ds_read_b64_tr_b16 v[120:121], v143 offset:0
    ds_read_b64_tr_b16 v[122:123], v143 offset:160
    s_nop 3
    v_smfmac_f32_32x32x32_bf16 v[64:79], v[132:135], v[40:47], v136
    ds_read_b64_tr_b16 v[124:125], v143 offset:640
    ds_read_b64_tr_b16 v[126:127], v143 offset:800
    s_nop 4
    v_mfma_f32_32x32x16_bf16 v[0:15], v[108:111], v[96:99], v[0:15]
    v_mfma_f32_32x32x16_bf16 v[16:31], v[108:111], v[100:103], v[16:31]
    v_smfmac_f32_32x32x32_bf16 v[80:95], v[128:131], v[48:55], v136
    v_smfmac_f32_32x32x32_bf16 v[80:95], v[132:135], v[56:63], v136
    s_nop 7
    s_setprio 0
    v_exp_f32 v0, v0
    v_exp_f32 v1, v1
    v_exp_f32 v2, v2
    v_exp_f32 v3, v3
    v_exp_f32 v4, v4
    v_exp_f32 v5, v5
    v_exp_f32 v6, v6
    v_exp_f32 v7, v7
    v_exp_f32 v8, v8
    v_exp_f32 v9, v9
    v_exp_f32 v10, v10
    v_exp_f32 v11, v11
    v_exp_f32 v12, v12
    v_exp_f32 v13, v13
    v_exp_f32 v14, v14
    v_exp_f32 v15, v15
    v_exp_f32 v16, v16
    s_setprio 2
    v_exp_f32 v17, v17
    v_exp_f32 v18, v18
    v_exp_f32 v19, v19
    v_exp_f32 v20, v20
    v_exp_f32 v21, v21
    v_exp_f32 v22, v22
    v_exp_f32 v23, v23
    v_exp_f32 v24, v24
    v_exp_f32 v25, v25
    v_exp_f32 v26, v26
    v_exp_f32 v27, v27
    v_exp_f32 v28, v28
    v_exp_f32 v29, v29
    v_exp_f32 v30, v30
    v_exp_f32 v31, v31
    s_setprio 3
    s_waitcnt lgkmcnt(0)
    v_mfma_f32_32x32x4_2b_bf16 v[32:63], v[112:113], v[104:105], 4.0 cbsz:1 abid:1
    ds_read_b64 v[118:119], v139 offset:23040
    ds_read_b64 v[108:109], v137 offset:23040
    ds_read_b64 v[110:111], v137 offset:23048
    buffer_load_dwordx4 v149, s[16:19], s43 offen offset:2048 lds
    v_smfmac_f32_32x32x32_bf16 v[64:79], v[120:123], v[0:7], v136
    ds_read_b64_tr_b16 v[128:129], v143 offset:1280
    ds_read_b64_tr_b16 v[130:131], v143 offset:1440
    s_nop 3
    v_smfmac_f32_32x32x32_bf16 v[64:79], v[124:127], v[8:15], v136
    ds_read_b64_tr_b16 v[132:133], v143 offset:1920
    ds_read_b64_tr_b16 v[134:135], v143 offset:2080
    s_nop 3
    v_mfma_f32_32x32x16_bf16 v[32:47], v[114:117], v[96:99], v[32:47]
    v_mfma_f32_32x32x16_bf16 v[48:63], v[114:117], v[100:103], v[48:63]
    v_smfmac_f32_32x32x32_bf16 v[80:95], v[120:123], v[16:23], v136
    v_smfmac_f32_32x32x32_bf16 v[80:95], v[124:127], v[24:31], v136
    s_nop 7
    s_setprio 0
    v_exp_f32 v32, v32
    v_exp_f32 v33, v33
    v_exp_f32 v34, v34
    v_exp_f32 v35, v35
    v_exp_f32 v36, v36
    v_exp_f32 v37, v37
    v_exp_f32 v38, v38
    v_exp_f32 v39, v39
    v_exp_f32 v40, v40
    v_exp_f32 v41, v41
    v_exp_f32 v42, v42
    v_exp_f32 v43, v43
    v_exp_f32 v44, v44
    v_exp_f32 v45, v45
    v_exp_f32 v46, v46
    v_exp_f32 v47, v47
    v_exp_f32 v48, v48
    s_setprio 2
    v_exp_f32 v49, v49
    v_exp_f32 v50, v50
    v_exp_f32 v51, v51
    v_exp_f32 v52, v52
    v_exp_f32 v53, v53
    v_exp_f32 v54, v54
    v_exp_f32 v55, v55
    v_exp_f32 v56, v56
    v_exp_f32 v57, v57
    v_exp_f32 v58, v58
    v_exp_f32 v59, v59
    v_exp_f32 v60, v60
    v_exp_f32 v61, v61
    v_exp_f32 v62, v62
    v_exp_f32 v63, v63
    s_setprio 3
    s_waitcnt lgkmcnt(0)
    v_mfma_f32_32x32x4_2b_bf16 v[0:31], v[118:119], v[104:105], 4.0 cbsz:1 abid:0
    ds_read_b64 v[114:115], v137 offset:24320
    ds_read_b64 v[116:117], v137 offset:24328
    buffer_load_dwordx4 v149, s[16:19], s43 offen offset:3072 lds
    v_smfmac_f32_32x32x32_bf16 v[64:79], v[128:131], v[32:39], v136
    ds_read_b64_tr_b16 v[120:121], v143 offset:2560
    ds_read_b64_tr_b16 v[122:123], v143 offset:2720
    s_nop 3
    v_smfmac_f32_32x32x32_bf16 v[64:79], v[132:135], v[40:47], v136
    ds_read_b64_tr_b16 v[124:125], v143 offset:3200
    ds_read_b64_tr_b16 v[126:127], v143 offset:3360
    s_nop 4
    v_mfma_f32_32x32x16_bf16 v[0:15], v[108:111], v[96:99], v[0:15]
    v_mfma_f32_32x32x16_bf16 v[16:31], v[108:111], v[100:103], v[16:31]
    v_smfmac_f32_32x32x32_bf16 v[80:95], v[128:131], v[48:55], v136
    v_smfmac_f32_32x32x32_bf16 v[80:95], v[132:135], v[56:63], v136
    s_nop 7
    s_setprio 0
    v_exp_f32 v0, v0
    v_exp_f32 v1, v1
    v_exp_f32 v2, v2
    v_exp_f32 v3, v3
    v_exp_f32 v4, v4
    v_exp_f32 v5, v5
    v_exp_f32 v6, v6
    v_exp_f32 v7, v7
    v_exp_f32 v8, v8
    v_exp_f32 v9, v9
    v_exp_f32 v10, v10
    v_exp_f32 v11, v11
    v_exp_f32 v12, v12
    v_exp_f32 v13, v13
    v_exp_f32 v14, v14
    v_exp_f32 v15, v15
    v_exp_f32 v16, v16
    s_setprio 2
    v_exp_f32 v17, v17
    v_exp_f32 v18, v18
    v_exp_f32 v19, v19
    v_exp_f32 v20, v20
    v_exp_f32 v21, v21
    v_exp_f32 v22, v22
    v_exp_f32 v23, v23
    v_exp_f32 v24, v24
    v_exp_f32 v25, v25
    v_exp_f32 v26, v26
    v_exp_f32 v27, v27
    v_exp_f32 v28, v28
    v_exp_f32 v29, v29
    v_exp_f32 v30, v30
    v_exp_f32 v31, v31
    s_setprio 3
    s_waitcnt lgkmcnt(0)
    v_mfma_f32_32x32x4_2b_bf16 v[32:63], v[118:119], v[104:105], 4.0 cbsz:1 abid:1
    ds_read_b64 v[112:113], v139 offset:25600
    ds_read_b64 v[108:109], v137 offset:25600
    ds_read_b64 v[110:111], v137 offset:25608
    s_add_u32 m0, s36, 45056
    s_add_u32 s43, s35, 45056
    buffer_load_dwordx4 v149, s[16:19], s43 offen lds
    v_smfmac_f32_32x32x32_bf16 v[64:79], v[120:123], v[0:7], v136
    ds_read_b64_tr_b16 v[128:129], v143 offset:3840
    ds_read_b64_tr_b16 v[130:131], v143 offset:4000
    s_nop 2
    v_smfmac_f32_32x32x32_bf16 v[64:79], v[124:127], v[8:15], v136
    ds_read_b64_tr_b16 v[132:133], v143 offset:4480
    ds_read_b64_tr_b16 v[134:135], v143 offset:4640
    s_nop 2
    v_mfma_f32_32x32x16_bf16 v[32:47], v[114:117], v[96:99], v[32:47]
    v_mfma_f32_32x32x16_bf16 v[48:63], v[114:117], v[100:103], v[48:63]
    v_smfmac_f32_32x32x32_bf16 v[80:95], v[120:123], v[16:23], v136
    v_smfmac_f32_32x32x32_bf16 v[80:95], v[124:127], v[24:31], v136
    s_nop 7
    s_setprio 0
    v_exp_f32 v32, v32
    v_exp_f32 v33, v33
    v_exp_f32 v34, v34
    v_exp_f32 v35, v35
    v_exp_f32 v36, v36
    v_exp_f32 v37, v37
    v_exp_f32 v38, v38
    v_exp_f32 v39, v39
    v_exp_f32 v40, v40
    v_exp_f32 v41, v41
    v_exp_f32 v42, v42
    v_exp_f32 v43, v43
    v_exp_f32 v44, v44
    v_exp_f32 v45, v45
    v_exp_f32 v46, v46
    v_exp_f32 v47, v47
    v_exp_f32 v48, v48
    s_setprio 2
    v_exp_f32 v49, v49
    v_exp_f32 v50, v50
    v_exp_f32 v51, v51
    v_exp_f32 v52, v52
    v_exp_f32 v53, v53
    v_exp_f32 v54, v54
    v_exp_f32 v55, v55
    v_exp_f32 v56, v56
    v_exp_f32 v57, v57
    v_exp_f32 v58, v58
    v_exp_f32 v59, v59
    v_exp_f32 v60, v60
    v_exp_f32 v61, v61
    v_exp_f32 v62, v62
    v_exp_f32 v63, v63
    s_setprio 3
    s_waitcnt lgkmcnt(0)
    v_mfma_f32_32x32x4_2b_bf16 v[0:31], v[112:113], v[104:105], 4.0 cbsz:1 abid:0
    ds_read_b64 v[114:115], v137 offset:26880
    ds_read_b64 v[116:117], v137 offset:26888
    s_add_u32 m0, s36, 61440
    s_add_u32 s43, s35, 61440
    buffer_load_dwordx4 v149, s[16:19], s43 offen lds
    v_smfmac_f32_32x32x32_bf16 v[64:79], v[128:131], v[32:39], v136
    ds_read_b64_tr_b16 v[120:121], v143 offset:5120
    ds_read_b64_tr_b16 v[122:123], v143 offset:5280
    s_nop 2
    v_smfmac_f32_32x32x32_bf16 v[64:79], v[132:135], v[40:47], v136
    ds_read_b64_tr_b16 v[124:125], v143 offset:5760
    ds_read_b64_tr_b16 v[126:127], v143 offset:5920
    s_nop 3
    v_mfma_f32_32x32x16_bf16 v[0:15], v[108:111], v[96:99], v[0:15]
    v_mfma_f32_32x32x16_bf16 v[16:31], v[108:111], v[100:103], v[16:31]
    v_smfmac_f32_32x32x32_bf16 v[80:95], v[128:131], v[48:55], v136
    v_smfmac_f32_32x32x32_bf16 v[80:95], v[132:135], v[56:63], v136
    s_nop 7
    s_setprio 0
    v_exp_f32 v0, v0
    v_exp_f32 v1, v1
    v_exp_f32 v2, v2
    v_exp_f32 v3, v3
    v_exp_f32 v4, v4
    v_exp_f32 v5, v5
    v_exp_f32 v6, v6
    v_exp_f32 v7, v7
    v_exp_f32 v8, v8
    v_exp_f32 v9, v9
    v_exp_f32 v10, v10
    v_exp_f32 v11, v11
    v_exp_f32 v12, v12
    v_exp_f32 v13, v13
    v_exp_f32 v14, v14
    v_exp_f32 v15, v15
    v_exp_f32 v16, v16
    s_setprio 2
    v_exp_f32 v17, v17
    v_exp_f32 v18, v18
    v_exp_f32 v19, v19
    v_exp_f32 v20, v20
    v_exp_f32 v21, v21
    v_exp_f32 v22, v22
    v_exp_f32 v23, v23
    v_exp_f32 v24, v24
    v_exp_f32 v25, v25
    v_exp_f32 v26, v26
    v_exp_f32 v27, v27
    v_exp_f32 v28, v28
    v_exp_f32 v29, v29
    v_exp_f32 v30, v30
    v_exp_f32 v31, v31
    s_setprio 3
    s_waitcnt lgkmcnt(0)
    v_mfma_f32_32x32x4_2b_bf16 v[32:63], v[112:113], v[104:105], 4.0 cbsz:1 abid:1
    ds_read_b64 v[118:119], v139 offset:28160
    ds_read_b64 v[108:109], v137 offset:28160
    ds_read_b64 v[110:111], v137 offset:28168
    buffer_load_dwordx4 v149, s[16:19], s43 offen offset:1024 lds
    v_smfmac_f32_32x32x32_bf16 v[64:79], v[120:123], v[0:7], v136
    ds_read_b64_tr_b16 v[128:129], v143 offset:6400
    ds_read_b64_tr_b16 v[130:131], v143 offset:6560
    s_nop 3
    v_smfmac_f32_32x32x32_bf16 v[64:79], v[124:127], v[8:15], v136
    ds_read_b64_tr_b16 v[132:133], v143 offset:7040
    ds_read_b64_tr_b16 v[134:135], v143 offset:7200
    s_nop 3
    v_mfma_f32_32x32x16_bf16 v[32:47], v[114:117], v[96:99], v[32:47]
    v_mfma_f32_32x32x16_bf16 v[48:63], v[114:117], v[100:103], v[48:63]
    v_smfmac_f32_32x32x32_bf16 v[80:95], v[120:123], v[16:23], v136
    v_smfmac_f32_32x32x32_bf16 v[80:95], v[124:127], v[24:31], v136
    s_nop 7
    s_setprio 0
    v_exp_f32 v32, v32
    v_exp_f32 v33, v33
    v_exp_f32 v34, v34
    v_exp_f32 v35, v35
    v_exp_f32 v36, v36
    v_exp_f32 v37, v37
    v_exp_f32 v38, v38
    v_exp_f32 v39, v39
    v_exp_f32 v40, v40
    v_exp_f32 v41, v41
    v_exp_f32 v42, v42
    v_exp_f32 v43, v43
    v_exp_f32 v44, v44
    v_exp_f32 v45, v45
    v_exp_f32 v46, v46
    v_exp_f32 v47, v47
    v_exp_f32 v48, v48
    s_setprio 2
    v_exp_f32 v49, v49
    v_exp_f32 v50, v50
    v_exp_f32 v51, v51
    v_exp_f32 v52, v52
    v_exp_f32 v53, v53
    v_exp_f32 v54, v54
    v_exp_f32 v55, v55
    v_exp_f32 v56, v56
    v_exp_f32 v57, v57
    v_exp_f32 v58, v58
    v_exp_f32 v59, v59
    v_exp_f32 v60, v60
    v_exp_f32 v61, v61
    v_exp_f32 v62, v62
    v_exp_f32 v63, v63
    s_setprio 3
    s_waitcnt lgkmcnt(0)
    v_mfma_f32_32x32x4_2b_bf16 v[0:31], v[118:119], v[104:105], 4.0 cbsz:1 abid:0
    ds_read_b64 v[114:115], v137 offset:29440
    ds_read_b64 v[116:117], v137 offset:29448
    buffer_load_dwordx4 v149, s[16:19], s43 offen offset:2048 lds
    v_smfmac_f32_32x32x32_bf16 v[64:79], v[128:131], v[32:39], v136
    ds_read_b64_tr_b16 v[120:121], v143 offset:7680
    ds_read_b64_tr_b16 v[122:123], v143 offset:7840
    s_nop 3
    v_smfmac_f32_32x32x32_bf16 v[64:79], v[132:135], v[40:47], v136
    ds_read_b64_tr_b16 v[124:125], v143 offset:8320
    ds_read_b64_tr_b16 v[126:127], v143 offset:8480
    s_nop 4
    v_mfma_f32_32x32x16_bf16 v[0:15], v[108:111], v[96:99], v[0:15]
    v_mfma_f32_32x32x16_bf16 v[16:31], v[108:111], v[100:103], v[16:31]
    v_smfmac_f32_32x32x32_bf16 v[80:95], v[128:131], v[48:55], v136
    v_smfmac_f32_32x32x32_bf16 v[80:95], v[132:135], v[56:63], v136
    s_nop 7
    s_setprio 0
    v_exp_f32 v0, v0
    v_exp_f32 v1, v1
    v_exp_f32 v2, v2
    v_exp_f32 v3, v3
    v_exp_f32 v4, v4
    v_exp_f32 v5, v5
    v_exp_f32 v6, v6
    v_exp_f32 v7, v7
    v_exp_f32 v8, v8
    v_exp_f32 v9, v9
    v_exp_f32 v10, v10
    v_exp_f32 v11, v11
    v_exp_f32 v12, v12
    v_exp_f32 v13, v13
    v_exp_f32 v14, v14
    v_exp_f32 v15, v15
    v_exp_f32 v16, v16
    s_setprio 2
    v_exp_f32 v17, v17
    v_exp_f32 v18, v18
    v_exp_f32 v19, v19
    v_exp_f32 v20, v20
    v_exp_f32 v21, v21
    v_exp_f32 v22, v22
    v_exp_f32 v23, v23
    v_exp_f32 v24, v24
    v_exp_f32 v25, v25
    v_exp_f32 v26, v26
    v_exp_f32 v27, v27
    v_exp_f32 v28, v28
    v_exp_f32 v29, v29
    v_exp_f32 v30, v30
    v_exp_f32 v31, v31
    s_setprio 3
    s_waitcnt lgkmcnt(0)
    v_mfma_f32_32x32x4_2b_bf16 v[32:63], v[118:119], v[104:105], 4.0 cbsz:1 abid:1
    ds_read_b64 v[112:113], v139 offset:30720
    ds_read_b64 v[108:109], v137 offset:30720
    ds_read_b64 v[110:111], v137 offset:30728
    buffer_load_dwordx4 v149, s[16:19], s43 offen offset:3072 lds
    v_smfmac_f32_32x32x32_bf16 v[64:79], v[120:123], v[0:7], v136
    ds_read_b64_tr_b16 v[128:129], v143 offset:8960
    ds_read_b64_tr_b16 v[130:131], v143 offset:9120
    s_nop 3
    v_smfmac_f32_32x32x32_bf16 v[64:79], v[124:127], v[8:15], v136
    ds_read_b64_tr_b16 v[132:133], v143 offset:9600
    ds_read_b64_tr_b16 v[134:135], v143 offset:9760
    s_nop 3
    v_mfma_f32_32x32x16_bf16 v[32:47], v[114:117], v[96:99], v[32:47]
    v_mfma_f32_32x32x16_bf16 v[48:63], v[114:117], v[100:103], v[48:63]
    v_smfmac_f32_32x32x32_bf16 v[80:95], v[120:123], v[16:23], v136
    v_smfmac_f32_32x32x32_bf16 v[80:95], v[124:127], v[24:31], v136
    s_nop 7
    s_setprio 0
    v_exp_f32 v32, v32
    v_exp_f32 v33, v33
    v_exp_f32 v34, v34
    v_exp_f32 v35, v35
    v_exp_f32 v36, v36
    v_exp_f32 v37, v37
    v_exp_f32 v38, v38
    v_exp_f32 v39, v39
    v_exp_f32 v40, v40
    v_exp_f32 v41, v41
    v_exp_f32 v42, v42
    v_exp_f32 v43, v43
    v_exp_f32 v44, v44
    v_exp_f32 v45, v45
    v_exp_f32 v46, v46
    v_exp_f32 v47, v47
    v_exp_f32 v48, v48
    s_setprio 2
    v_exp_f32 v49, v49
    v_exp_f32 v50, v50
    v_exp_f32 v51, v51
    v_exp_f32 v52, v52
    v_exp_f32 v53, v53
    v_exp_f32 v54, v54
    v_exp_f32 v55, v55
    v_exp_f32 v56, v56
    v_exp_f32 v57, v57
    v_exp_f32 v58, v58
    v_exp_f32 v59, v59
    v_exp_f32 v60, v60
    v_exp_f32 v61, v61
    v_exp_f32 v62, v62
    v_exp_f32 v63, v63
    s_setprio 3
    s_waitcnt lgkmcnt(0)
    v_mfma_f32_32x32x4_2b_bf16 v[0:31], v[112:113], v[104:105], 4.0 cbsz:1 abid:0
    ds_read_b64 v[114:115], v137 offset:32000
    ds_read_b64 v[116:117], v137 offset:32008
    s_add_u32 m0, s36, 65536
    s_add_u32 s43, s35, 65536
    buffer_load_dwordx4 v149, s[16:19], s43 offen lds
    v_smfmac_f32_32x32x32_bf16 v[64:79], v[128:131], v[32:39], v136
    ds_read_b64_tr_b16 v[120:121], v144 offset:0
    ds_read_b64_tr_b16 v[122:123], v144 offset:160
    s_nop 2
    v_smfmac_f32_32x32x32_bf16 v[64:79], v[132:135], v[40:47], v136
    ds_read_b64_tr_b16 v[124:125], v144 offset:640
    ds_read_b64_tr_b16 v[126:127], v144 offset:800
    s_nop 3
    v_mfma_f32_32x32x16_bf16 v[0:15], v[108:111], v[96:99], v[0:15]
    v_mfma_f32_32x32x16_bf16 v[16:31], v[108:111], v[100:103], v[16:31]
    v_smfmac_f32_32x32x32_bf16 v[80:95], v[128:131], v[48:55], v136
    v_smfmac_f32_32x32x32_bf16 v[80:95], v[132:135], v[56:63], v136
    s_nop 7
    s_setprio 0
    v_exp_f32 v0, v0
    v_exp_f32 v1, v1
    v_exp_f32 v2, v2
    v_exp_f32 v3, v3
    v_exp_f32 v4, v4
    v_exp_f32 v5, v5
    v_exp_f32 v6, v6
    v_exp_f32 v7, v7
    v_exp_f32 v8, v8
    v_exp_f32 v9, v9
    v_exp_f32 v10, v10
    v_exp_f32 v11, v11
    v_exp_f32 v12, v12
    v_exp_f32 v13, v13
    v_exp_f32 v14, v14
    v_exp_f32 v15, v15
    v_exp_f32 v16, v16
    s_setprio 2
    v_exp_f32 v17, v17
    v_exp_f32 v18, v18
    v_exp_f32 v19, v19
    v_exp_f32 v20, v20
    v_exp_f32 v21, v21
    v_exp_f32 v22, v22
    v_exp_f32 v23, v23
    v_exp_f32 v24, v24
    v_exp_f32 v25, v25
    v_exp_f32 v26, v26
    v_exp_f32 v27, v27
    v_exp_f32 v28, v28
    v_exp_f32 v29, v29
    v_exp_f32 v30, v30
    v_exp_f32 v31, v31
    s_setprio 3
    s_waitcnt lgkmcnt(0)
    v_mfma_f32_32x32x4_2b_bf16 v[32:63], v[112:113], v[104:105], 4.0 cbsz:1 abid:1
    ds_read_b64 v[118:119], v139 offset:33280
    ds_read_b64 v[108:109], v137 offset:33280
    ds_read_b64 v[110:111], v137 offset:33288
    v_smfmac_f32_32x32x32_bf16 v[64:79], v[120:123], v[0:7], v136
    ds_read_b64_tr_b16 v[128:129], v144 offset:1280
    ds_read_b64_tr_b16 v[130:131], v144 offset:1440
    s_nop 3
    v_smfmac_f32_32x32x32_bf16 v[64:79], v[124:127], v[8:15], v136
    ds_read_b64_tr_b16 v[132:133], v144 offset:1920
    ds_read_b64_tr_b16 v[134:135], v144 offset:2080
    s_nop 4
    v_mfma_f32_32x32x16_bf16 v[32:47], v[114:117], v[96:99], v[32:47]
    v_mfma_f32_32x32x16_bf16 v[48:63], v[114:117], v[100:103], v[48:63]
    v_smfmac_f32_32x32x32_bf16 v[80:95], v[120:123], v[16:23], v136
    v_smfmac_f32_32x32x32_bf16 v[80:95], v[124:127], v[24:31], v136
    s_nop 7
    s_setprio 0
    v_exp_f32 v32, v32
    v_exp_f32 v33, v33
    v_exp_f32 v34, v34
    v_exp_f32 v35, v35
    v_exp_f32 v36, v36
    v_exp_f32 v37, v37
    v_exp_f32 v38, v38
    v_exp_f32 v39, v39
    v_exp_f32 v40, v40
    v_exp_f32 v41, v41
    v_exp_f32 v42, v42
    v_exp_f32 v43, v43
    v_exp_f32 v44, v44
    v_exp_f32 v45, v45
    v_exp_f32 v46, v46
    v_exp_f32 v47, v47
    v_exp_f32 v48, v48
    s_setprio 2
    v_exp_f32 v49, v49
    v_exp_f32 v50, v50
    v_exp_f32 v51, v51
    v_exp_f32 v52, v52
    v_exp_f32 v53, v53
    v_exp_f32 v54, v54
    v_exp_f32 v55, v55
    v_exp_f32 v56, v56
    v_exp_f32 v57, v57
    v_exp_f32 v58, v58
    v_exp_f32 v59, v59
    v_exp_f32 v60, v60
    v_exp_f32 v61, v61
    v_exp_f32 v62, v62
    v_exp_f32 v63, v63
    s_setprio 3
    s_waitcnt lgkmcnt(0)
    v_mfma_f32_32x32x4_2b_bf16 v[0:31], v[118:119], v[104:105], 4.0 cbsz:1 abid:0
    ds_read_b64 v[114:115], v137 offset:34560
    ds_read_b64 v[116:117], v137 offset:34568
    v_smfmac_f32_32x32x32_bf16 v[64:79], v[128:131], v[32:39], v136
    ds_read_b64_tr_b16 v[120:121], v144 offset:2560
    ds_read_b64_tr_b16 v[122:123], v144 offset:2720
    s_nop 4
    v_smfmac_f32_32x32x32_bf16 v[64:79], v[132:135], v[40:47], v136
    ds_read_b64_tr_b16 v[124:125], v144 offset:3200
    ds_read_b64_tr_b16 v[126:127], v144 offset:3360
    s_nop 4
    v_mfma_f32_32x32x16_bf16 v[0:15], v[108:111], v[96:99], v[0:15]
    v_mfma_f32_32x32x16_bf16 v[16:31], v[108:111], v[100:103], v[16:31]
    v_smfmac_f32_32x32x32_bf16 v[80:95], v[128:131], v[48:55], v136
    v_smfmac_f32_32x32x32_bf16 v[80:95], v[132:135], v[56:63], v136
    s_nop 7
    s_setprio 0
    v_exp_f32 v0, v0
    v_exp_f32 v1, v1
    v_exp_f32 v2, v2
    v_exp_f32 v3, v3
    v_exp_f32 v4, v4
    v_exp_f32 v5, v5
    v_exp_f32 v6, v6
    v_exp_f32 v7, v7
    v_exp_f32 v8, v8
    v_exp_f32 v9, v9
    v_exp_f32 v10, v10
    v_exp_f32 v11, v11
    v_exp_f32 v12, v12
    v_exp_f32 v13, v13
    v_exp_f32 v14, v14
    v_exp_f32 v15, v15
    v_exp_f32 v16, v16
    s_setprio 2
    v_exp_f32 v17, v17
    v_exp_f32 v18, v18
    v_exp_f32 v19, v19
    v_exp_f32 v20, v20
    v_exp_f32 v21, v21
    v_exp_f32 v22, v22
    v_exp_f32 v23, v23
    v_exp_f32 v24, v24
    v_exp_f32 v25, v25
    v_exp_f32 v26, v26
    v_exp_f32 v27, v27
    v_exp_f32 v28, v28
    v_exp_f32 v29, v29
    v_exp_f32 v30, v30
    v_exp_f32 v31, v31
    s_setprio 3
    s_waitcnt lgkmcnt(0)
    v_mfma_f32_32x32x4_2b_bf16 v[32:63], v[118:119], v[104:105], 4.0 cbsz:1 abid:1
    ds_read_b64 v[112:113], v139 offset:35840
    ds_read_b64 v[108:109], v137 offset:35840
    ds_read_b64 v[110:111], v137 offset:35848
    v_smfmac_f32_32x32x32_bf16 v[64:79], v[120:123], v[0:7], v136
    ds_read_b64_tr_b16 v[128:129], v144 offset:3840
    ds_read_b64_tr_b16 v[130:131], v144 offset:4000
    s_nop 3
    v_smfmac_f32_32x32x32_bf16 v[64:79], v[124:127], v[8:15], v136
    ds_read_b64_tr_b16 v[132:133], v144 offset:4480
    ds_read_b64_tr_b16 v[134:135], v144 offset:4640
    s_nop 4
    v_mfma_f32_32x32x16_bf16 v[32:47], v[114:117], v[96:99], v[32:47]
    v_mfma_f32_32x32x16_bf16 v[48:63], v[114:117], v[100:103], v[48:63]
    v_smfmac_f32_32x32x32_bf16 v[80:95], v[120:123], v[16:23], v136
    v_smfmac_f32_32x32x32_bf16 v[80:95], v[124:127], v[24:31], v136
    s_nop 7
    s_setprio 0
    v_exp_f32 v32, v32
    v_exp_f32 v33, v33
    v_exp_f32 v34, v34
    v_exp_f32 v35, v35
    v_exp_f32 v36, v36
    v_exp_f32 v37, v37
    v_exp_f32 v38, v38
    v_exp_f32 v39, v39
    v_exp_f32 v40, v40
    v_exp_f32 v41, v41
    v_exp_f32 v42, v42
    v_exp_f32 v43, v43
    v_exp_f32 v44, v44
    v_exp_f32 v45, v45
    v_exp_f32 v46, v46
    v_exp_f32 v47, v47
    v_exp_f32 v48, v48
    s_setprio 2
    v_exp_f32 v49, v49
    v_exp_f32 v50, v50
    v_exp_f32 v51, v51
    v_exp_f32 v52, v52
    v_exp_f32 v53, v53
    v_exp_f32 v54, v54
    v_exp_f32 v55, v55
    v_exp_f32 v56, v56
    v_exp_f32 v57, v57
    v_exp_f32 v58, v58
    v_exp_f32 v59, v59
    v_exp_f32 v60, v60
    v_exp_f32 v61, v61
    v_exp_f32 v62, v62
    v_exp_f32 v63, v63
    s_setprio 3
    s_waitcnt lgkmcnt(0)
    v_mfma_f32_32x32x4_2b_bf16 v[0:31], v[112:113], v[104:105], 4.0 cbsz:1 abid:0
    ds_read_b64 v[114:115], v137 offset:37120
    ds_read_b64 v[116:117], v137 offset:37128
    v_smfmac_f32_32x32x32_bf16 v[64:79], v[128:131], v[32:39], v136
    ds_read_b64_tr_b16 v[120:121], v144 offset:5120
    ds_read_b64_tr_b16 v[122:123], v144 offset:5280
    s_nop 4
    v_smfmac_f32_32x32x32_bf16 v[64:79], v[132:135], v[40:47], v136
    ds_read_b64_tr_b16 v[124:125], v144 offset:5760
    ds_read_b64_tr_b16 v[126:127], v144 offset:5920
    s_nop 4
    v_mfma_f32_32x32x16_bf16 v[0:15], v[108:111], v[96:99], v[0:15]
    v_mfma_f32_32x32x16_bf16 v[16:31], v[108:111], v[100:103], v[16:31]
    v_smfmac_f32_32x32x32_bf16 v[80:95], v[128:131], v[48:55], v136
    v_smfmac_f32_32x32x32_bf16 v[80:95], v[132:135], v[56:63], v136
    s_nop 7
    s_setprio 0
    v_exp_f32 v0, v0
    v_exp_f32 v1, v1
    v_exp_f32 v2, v2
    v_exp_f32 v3, v3
    v_exp_f32 v4, v4
    v_exp_f32 v5, v5
    v_exp_f32 v6, v6
    v_exp_f32 v7, v7
    v_exp_f32 v8, v8
    v_exp_f32 v9, v9
    v_exp_f32 v10, v10
    v_exp_f32 v11, v11
    v_exp_f32 v12, v12
    v_exp_f32 v13, v13
    v_exp_f32 v14, v14
    v_exp_f32 v15, v15
    v_exp_f32 v16, v16
    s_setprio 2
    v_exp_f32 v17, v17
    v_exp_f32 v18, v18
    v_exp_f32 v19, v19
    v_exp_f32 v20, v20
    v_exp_f32 v21, v21
    v_exp_f32 v22, v22
    v_exp_f32 v23, v23
    v_exp_f32 v24, v24
    v_exp_f32 v25, v25
    v_exp_f32 v26, v26
    v_exp_f32 v27, v27
    v_exp_f32 v28, v28
    v_exp_f32 v29, v29
    v_exp_f32 v30, v30
    v_exp_f32 v31, v31
    s_setprio 3
    s_waitcnt lgkmcnt(0)
    v_mfma_f32_32x32x4_2b_bf16 v[32:63], v[112:113], v[104:105], 4.0 cbsz:1 abid:1
    ds_read_b64 v[118:119], v139 offset:38400
    ds_read_b64 v[108:109], v137 offset:38400
    ds_read_b64 v[110:111], v137 offset:38408
    v_smfmac_f32_32x32x32_bf16 v[64:79], v[120:123], v[0:7], v136
    ds_read_b64_tr_b16 v[128:129], v144 offset:6400
    ds_read_b64_tr_b16 v[130:131], v144 offset:6560
    s_nop 3
    v_smfmac_f32_32x32x32_bf16 v[64:79], v[124:127], v[8:15], v136
    ds_read_b64_tr_b16 v[132:133], v144 offset:7040
    ds_read_b64_tr_b16 v[134:135], v144 offset:7200
    s_nop 4
    v_mfma_f32_32x32x16_bf16 v[32:47], v[114:117], v[96:99], v[32:47]
    v_mfma_f32_32x32x16_bf16 v[48:63], v[114:117], v[100:103], v[48:63]
    v_smfmac_f32_32x32x32_bf16 v[80:95], v[120:123], v[16:23], v136
    v_smfmac_f32_32x32x32_bf16 v[80:95], v[124:127], v[24:31], v136
    s_nop 7
    s_setprio 0
    v_exp_f32 v32, v32
    v_exp_f32 v33, v33
    v_exp_f32 v34, v34
    v_exp_f32 v35, v35
    v_exp_f32 v36, v36
    v_exp_f32 v37, v37
    v_exp_f32 v38, v38
    v_exp_f32 v39, v39
    v_exp_f32 v40, v40
    v_exp_f32 v41, v41
    v_exp_f32 v42, v42
    v_exp_f32 v43, v43
    v_exp_f32 v44, v44
    v_exp_f32 v45, v45
    v_exp_f32 v46, v46
    v_exp_f32 v47, v47
    v_exp_f32 v48, v48
    s_setprio 2
    v_exp_f32 v49, v49
    v_exp_f32 v50, v50
    v_exp_f32 v51, v51
    v_exp_f32 v52, v52
    v_exp_f32 v53, v53
    v_exp_f32 v54, v54
    v_exp_f32 v55, v55
    v_exp_f32 v56, v56
    v_exp_f32 v57, v57
    v_exp_f32 v58, v58
    v_exp_f32 v59, v59
    v_exp_f32 v60, v60
    v_exp_f32 v61, v61
    v_exp_f32 v62, v62
    v_exp_f32 v63, v63
    s_setprio 3
    s_waitcnt lgkmcnt(0)
    v_mfma_f32_32x32x4_2b_bf16 v[0:31], v[118:119], v[104:105], 4.0 cbsz:1 abid:0
    ds_read_b64 v[114:115], v137 offset:39680
    ds_read_b64 v[116:117], v137 offset:39688
    v_smfmac_f32_32x32x32_bf16 v[64:79], v[128:131], v[32:39], v136
    ds_read_b64_tr_b16 v[120:121], v144 offset:7680
    ds_read_b64_tr_b16 v[122:123], v144 offset:7840
    s_nop 4
    v_smfmac_f32_32x32x32_bf16 v[64:79], v[132:135], v[40:47], v136
    ds_read_b64_tr_b16 v[124:125], v144 offset:8320
    ds_read_b64_tr_b16 v[126:127], v144 offset:8480
    s_nop 4
    v_mfma_f32_32x32x16_bf16 v[0:15], v[108:111], v[96:99], v[0:15]
    v_mfma_f32_32x32x16_bf16 v[16:31], v[108:111], v[100:103], v[16:31]
    v_smfmac_f32_32x32x32_bf16 v[80:95], v[128:131], v[48:55], v136
    v_smfmac_f32_32x32x32_bf16 v[80:95], v[132:135], v[56:63], v136
    s_nop 7
    s_setprio 0
    v_exp_f32 v0, v0
    v_exp_f32 v1, v1
    v_exp_f32 v2, v2
    v_exp_f32 v3, v3
    v_exp_f32 v4, v4
    v_exp_f32 v5, v5
    v_exp_f32 v6, v6
    v_exp_f32 v7, v7
    v_exp_f32 v8, v8
    v_exp_f32 v9, v9
    v_exp_f32 v10, v10
    v_exp_f32 v11, v11
    v_exp_f32 v12, v12
    v_exp_f32 v13, v13
    v_exp_f32 v14, v14
    v_exp_f32 v15, v15
    v_exp_f32 v16, v16
    s_setprio 2
    v_exp_f32 v17, v17
    v_exp_f32 v18, v18
    v_exp_f32 v19, v19
    v_exp_f32 v20, v20
    v_exp_f32 v21, v21
    v_exp_f32 v22, v22
    v_exp_f32 v23, v23
    v_exp_f32 v24, v24
    v_exp_f32 v25, v25
    v_exp_f32 v26, v26
    v_exp_f32 v27, v27
    v_exp_f32 v28, v28
    v_exp_f32 v29, v29
    v_exp_f32 v30, v30
    v_exp_f32 v31, v31
    s_setprio 3
    s_waitcnt vmcnt(0) lgkmcnt(0)
    s_barrier
    v_mfma_f32_32x32x4_2b_bf16 v[32:63], v[118:119], v[104:105], 4.0 cbsz:1 abid:1
    ds_read_b64 v[112:113], v139 offset:40960
    ds_read_b64 v[108:109], v137 offset:40960
    ds_read_b64 v[110:111], v137 offset:40968
    v_smfmac_f32_32x32x32_bf16 v[64:79], v[120:123], v[0:7], v136
    ds_read_b64_tr_b16 v[128:129], v144 offset:8960
    ds_read_b64_tr_b16 v[130:131], v144 offset:9120
    s_nop 3
    v_smfmac_f32_32x32x32_bf16 v[64:79], v[124:127], v[8:15], v136
    ds_read_b64_tr_b16 v[132:133], v144 offset:9600
    ds_read_b64_tr_b16 v[134:135], v144 offset:9760
    s_nop 4
    v_mfma_f32_32x32x16_bf16 v[32:47], v[114:117], v[96:99], v[32:47]
    v_mfma_f32_32x32x16_bf16 v[48:63], v[114:117], v[100:103], v[48:63]
    v_smfmac_f32_32x32x32_bf16 v[80:95], v[120:123], v[16:23], v136
    v_smfmac_f32_32x32x32_bf16 v[80:95], v[124:127], v[24:31], v136
    s_nop 7
    s_setprio 0
    v_exp_f32 v32, v32
    v_exp_f32 v33, v33
    v_exp_f32 v34, v34
    v_exp_f32 v35, v35
    v_exp_f32 v36, v36
    v_exp_f32 v37, v37
    v_exp_f32 v38, v38
    v_exp_f32 v39, v39
    v_exp_f32 v40, v40
    v_exp_f32 v41, v41
    v_exp_f32 v42, v42
    v_exp_f32 v43, v43
    v_exp_f32 v44, v44
    v_exp_f32 v45, v45
    v_exp_f32 v46, v46
    v_exp_f32 v47, v47
    v_exp_f32 v48, v48
    s_setprio 2
    v_exp_f32 v49, v49
    v_exp_f32 v50, v50
    v_exp_f32 v51, v51
    v_exp_f32 v52, v52
    v_exp_f32 v53, v53
    v_exp_f32 v54, v54
    v_exp_f32 v55, v55
    v_exp_f32 v56, v56
    v_exp_f32 v57, v57
    v_exp_f32 v58, v58
    v_exp_f32 v59, v59
    v_exp_f32 v60, v60
    v_exp_f32 v61, v61
    v_exp_f32 v62, v62
    v_exp_f32 v63, v63
    s_setprio 3
    s_waitcnt lgkmcnt(0)
    v_mfma_f32_32x32x4_2b_bf16 v[0:31], v[112:113], v[104:105], 4.0 cbsz:1 abid:0
    ds_read_b64 v[114:115], v137 offset:42240
    ds_read_b64 v[116:117], v137 offset:42248
    v_smfmac_f32_32x32x32_bf16 v[64:79], v[128:131], v[32:39], v136
    ds_read_b64_tr_b16 v[120:121], v145 offset:0
    ds_read_b64_tr_b16 v[122:123], v145 offset:160
    s_nop 4
    v_smfmac_f32_32x32x32_bf16 v[64:79], v[132:135], v[40:47], v136
    ds_read_b64_tr_b16 v[124:125], v145 offset:640
    ds_read_b64_tr_b16 v[126:127], v145 offset:800
    s_nop 4
    v_mfma_f32_32x32x16_bf16 v[0:15], v[108:111], v[96:99], v[0:15]
    v_mfma_f32_32x32x16_bf16 v[16:31], v[108:111], v[100:103], v[16:31]
    v_smfmac_f32_32x32x32_bf16 v[80:95], v[128:131], v[48:55], v136
    v_smfmac_f32_32x32x32_bf16 v[80:95], v[132:135], v[56:63], v136
    s_nop 7
    s_setprio 0
    v_exp_f32 v0, v0
    v_exp_f32 v1, v1
    v_exp_f32 v2, v2
    v_exp_f32 v3, v3
    v_exp_f32 v4, v4
    v_exp_f32 v5, v5
    v_exp_f32 v6, v6
    v_exp_f32 v7, v7
    v_exp_f32 v8, v8
    v_exp_f32 v9, v9
    v_exp_f32 v10, v10
    v_exp_f32 v11, v11
    v_exp_f32 v12, v12
    v_exp_f32 v13, v13
    v_exp_f32 v14, v14
    v_exp_f32 v15, v15
    v_exp_f32 v16, v16
    s_setprio 2
    v_exp_f32 v17, v17
    v_exp_f32 v18, v18
    v_exp_f32 v19, v19
    v_exp_f32 v20, v20
    v_exp_f32 v21, v21
    v_exp_f32 v22, v22
    v_exp_f32 v23, v23
    v_exp_f32 v24, v24
    v_exp_f32 v25, v25
    v_exp_f32 v26, v26
    v_exp_f32 v27, v27
    v_exp_f32 v28, v28
    v_exp_f32 v29, v29
    v_exp_f32 v30, v30
    v_exp_f32 v31, v31
    s_setprio 3
    s_waitcnt lgkmcnt(0)
    v_mfma_f32_32x32x4_2b_bf16 v[32:63], v[112:113], v[104:105], 4.0 cbsz:1 abid:1
    ds_read_b64 v[118:119], v139 offset:43520
    ds_read_b64 v[108:109], v137 offset:43520
    ds_read_b64 v[110:111], v137 offset:43528
    v_smfmac_f32_32x32x32_bf16 v[64:79], v[120:123], v[0:7], v136
    ds_read_b64_tr_b16 v[128:129], v145 offset:1280
    ds_read_b64_tr_b16 v[130:131], v145 offset:1440
    s_nop 3
    v_smfmac_f32_32x32x32_bf16 v[64:79], v[124:127], v[8:15], v136
    ds_read_b64_tr_b16 v[132:133], v145 offset:1920
    ds_read_b64_tr_b16 v[134:135], v145 offset:2080
    s_nop 4
    v_mfma_f32_32x32x16_bf16 v[32:47], v[114:117], v[96:99], v[32:47]
    v_mfma_f32_32x32x16_bf16 v[48:63], v[114:117], v[100:103], v[48:63]
    v_smfmac_f32_32x32x32_bf16 v[80:95], v[120:123], v[16:23], v136
    v_smfmac_f32_32x32x32_bf16 v[80:95], v[124:127], v[24:31], v136
    s_nop 7
    s_setprio 0
    v_exp_f32 v32, v32
    v_exp_f32 v33, v33
    v_exp_f32 v34, v34
    v_exp_f32 v35, v35
    v_exp_f32 v36, v36
    v_exp_f32 v37, v37
    v_exp_f32 v38, v38
    v_exp_f32 v39, v39
    v_exp_f32 v40, v40
    v_exp_f32 v41, v41
    v_exp_f32 v42, v42
    v_exp_f32 v43, v43
    v_exp_f32 v44, v44
    v_exp_f32 v45, v45
    v_exp_f32 v46, v46
    v_exp_f32 v47, v47
    v_exp_f32 v48, v48
    s_setprio 2
    v_exp_f32 v49, v49
    v_exp_f32 v50, v50
    v_exp_f32 v51, v51
    v_exp_f32 v52, v52
    v_exp_f32 v53, v53
    v_exp_f32 v54, v54
    v_exp_f32 v55, v55
    v_exp_f32 v56, v56
    v_exp_f32 v57, v57
    v_exp_f32 v58, v58
    v_exp_f32 v59, v59
    v_exp_f32 v60, v60
    v_exp_f32 v61, v61
    v_exp_f32 v62, v62
    v_exp_f32 v63, v63
    s_setprio 3
    s_waitcnt lgkmcnt(0)
    v_mfma_f32_32x32x4_2b_bf16 v[0:31], v[118:119], v[104:105], 4.0 cbsz:1 abid:0
    ds_read_b64 v[114:115], v137 offset:44800
    ds_read_b64 v[116:117], v137 offset:44808
    v_smfmac_f32_32x32x32_bf16 v[64:79], v[128:131], v[32:39], v136
    ds_read_b64_tr_b16 v[120:121], v145 offset:2560
    ds_read_b64_tr_b16 v[122:123], v145 offset:2720
    s_nop 4
    v_smfmac_f32_32x32x32_bf16 v[64:79], v[132:135], v[40:47], v136
    ds_read_b64_tr_b16 v[124:125], v145 offset:3200
    ds_read_b64_tr_b16 v[126:127], v145 offset:3360
    s_nop 4
    v_mfma_f32_32x32x16_bf16 v[0:15], v[108:111], v[96:99], v[0:15]
    v_mfma_f32_32x32x16_bf16 v[16:31], v[108:111], v[100:103], v[16:31]
    v_smfmac_f32_32x32x32_bf16 v[80:95], v[128:131], v[48:55], v136
    v_smfmac_f32_32x32x32_bf16 v[80:95], v[132:135], v[56:63], v136
    s_nop 7
    s_setprio 0
    v_exp_f32 v0, v0
    v_exp_f32 v1, v1
    v_exp_f32 v2, v2
    v_exp_f32 v3, v3
    v_exp_f32 v4, v4
    v_exp_f32 v5, v5
    v_exp_f32 v6, v6
    v_exp_f32 v7, v7
    v_exp_f32 v8, v8
    v_exp_f32 v9, v9
    v_exp_f32 v10, v10
    v_exp_f32 v11, v11
    v_exp_f32 v12, v12
    v_exp_f32 v13, v13
    v_exp_f32 v14, v14
    v_exp_f32 v15, v15
    v_exp_f32 v16, v16
    s_setprio 2
    v_exp_f32 v17, v17
    v_exp_f32 v18, v18
    v_exp_f32 v19, v19
    v_exp_f32 v20, v20
    v_exp_f32 v21, v21
    v_exp_f32 v22, v22
    v_exp_f32 v23, v23
    v_exp_f32 v24, v24
    v_exp_f32 v25, v25
    v_exp_f32 v26, v26
    v_exp_f32 v27, v27
    v_exp_f32 v28, v28
    v_exp_f32 v29, v29
    v_exp_f32 v30, v30
    v_exp_f32 v31, v31
    s_setprio 3
    s_waitcnt lgkmcnt(0)
    v_mfma_f32_32x32x4_2b_bf16 v[32:63], v[118:119], v[104:105], 4.0 cbsz:1 abid:1
    ds_read_b64 v[112:113], v139 offset:46080
    ds_read_b64 v[108:109], v137 offset:46080
    ds_read_b64 v[110:111], v137 offset:46088
    v_smfmac_f32_32x32x32_bf16 v[64:79], v[120:123], v[0:7], v136
    ds_read_b64_tr_b16 v[128:129], v145 offset:3840
    ds_read_b64_tr_b16 v[130:131], v145 offset:4000
    s_nop 3
    v_smfmac_f32_32x32x32_bf16 v[64:79], v[124:127], v[8:15], v136
    ds_read_b64_tr_b16 v[132:133], v145 offset:4480
    ds_read_b64_tr_b16 v[134:135], v145 offset:4640
    s_nop 4
    v_mfma_f32_32x32x16_bf16 v[32:47], v[114:117], v[96:99], v[32:47]
    v_mfma_f32_32x32x16_bf16 v[48:63], v[114:117], v[100:103], v[48:63]
    v_smfmac_f32_32x32x32_bf16 v[80:95], v[120:123], v[16:23], v136
    v_smfmac_f32_32x32x32_bf16 v[80:95], v[124:127], v[24:31], v136
    s_nop 7
    s_setprio 0
    v_exp_f32 v32, v32
    v_exp_f32 v33, v33
    v_exp_f32 v34, v34
    v_exp_f32 v35, v35
    v_exp_f32 v36, v36
    v_exp_f32 v37, v37
    v_exp_f32 v38, v38
    v_exp_f32 v39, v39
    v_exp_f32 v40, v40
    v_exp_f32 v41, v41
    v_exp_f32 v42, v42
    v_exp_f32 v43, v43
    v_exp_f32 v44, v44
    v_exp_f32 v45, v45
    v_exp_f32 v46, v46
    v_exp_f32 v47, v47
    v_exp_f32 v48, v48
    s_setprio 2
    v_exp_f32 v49, v49
    v_exp_f32 v50, v50
    v_exp_f32 v51, v51
    v_exp_f32 v52, v52
    v_exp_f32 v53, v53
    v_exp_f32 v54, v54
    v_exp_f32 v55, v55
    v_exp_f32 v56, v56
    v_exp_f32 v57, v57
    v_exp_f32 v58, v58
    v_exp_f32 v59, v59
    v_exp_f32 v60, v60
    v_exp_f32 v61, v61
    v_exp_f32 v62, v62
    v_exp_f32 v63, v63
    s_setprio 3
    s_waitcnt lgkmcnt(0)
    v_mfma_f32_32x32x4_2b_bf16 v[0:31], v[112:113], v[104:105], 4.0 cbsz:1 abid:0
    ds_read_b64 v[114:115], v137 offset:47360
    ds_read_b64 v[116:117], v137 offset:47368
    v_smfmac_f32_32x32x32_bf16 v[64:79], v[128:131], v[32:39], v136
    ds_read_b64_tr_b16 v[120:121], v145 offset:5120
    ds_read_b64_tr_b16 v[122:123], v145 offset:5280
    s_nop 4
    v_smfmac_f32_32x32x32_bf16 v[64:79], v[132:135], v[40:47], v136
    ds_read_b64_tr_b16 v[124:125], v145 offset:5760
    ds_read_b64_tr_b16 v[126:127], v145 offset:5920
    s_nop 4
    v_mfma_f32_32x32x16_bf16 v[0:15], v[108:111], v[96:99], v[0:15]
    v_mfma_f32_32x32x16_bf16 v[16:31], v[108:111], v[100:103], v[16:31]
    v_smfmac_f32_32x32x32_bf16 v[80:95], v[128:131], v[48:55], v136
    v_smfmac_f32_32x32x32_bf16 v[80:95], v[132:135], v[56:63], v136
    s_nop 7
    s_setprio 0
    v_exp_f32 v0, v0
    v_exp_f32 v1, v1
    v_exp_f32 v2, v2
    v_exp_f32 v3, v3
    v_exp_f32 v4, v4
    v_exp_f32 v5, v5
    v_exp_f32 v6, v6
    v_exp_f32 v7, v7
    v_exp_f32 v8, v8
    v_exp_f32 v9, v9
    v_exp_f32 v10, v10
    v_exp_f32 v11, v11
    v_exp_f32 v12, v12
    v_exp_f32 v13, v13
    v_exp_f32 v14, v14
    v_exp_f32 v15, v15
    v_exp_f32 v16, v16
    s_setprio 2
    v_exp_f32 v17, v17
    v_exp_f32 v18, v18
    v_exp_f32 v19, v19
    v_exp_f32 v20, v20
    v_exp_f32 v21, v21
    v_exp_f32 v22, v22
    v_exp_f32 v23, v23
    v_exp_f32 v24, v24
    v_exp_f32 v25, v25
    v_exp_f32 v26, v26
    v_exp_f32 v27, v27
    v_exp_f32 v28, v28
    v_exp_f32 v29, v29
    v_exp_f32 v30, v30
    v_exp_f32 v31, v31
    s_setprio 3
    s_waitcnt lgkmcnt(0)
    v_mfma_f32_32x32x4_2b_bf16 v[32:63], v[112:113], v[104:105], 4.0 cbsz:1 abid:1
    ds_read_b64 v[118:119], v139 offset:48640
    ds_read_b64 v[108:109], v137 offset:48640
    ds_read_b64 v[110:111], v137 offset:48648
    v_smfmac_f32_32x32x32_bf16 v[64:79], v[120:123], v[0:7], v136
    ds_read_b64_tr_b16 v[128:129], v145 offset:6400
    ds_read_b64_tr_b16 v[130:131], v145 offset:6560
    s_nop 3
    v_smfmac_f32_32x32x32_bf16 v[64:79], v[124:127], v[8:15], v136
    ds_read_b64_tr_b16 v[132:133], v145 offset:7040
    ds_read_b64_tr_b16 v[134:135], v145 offset:7200
    s_nop 4
    v_mfma_f32_32x32x16_bf16 v[32:47], v[114:117], v[96:99], v[32:47]
    v_mfma_f32_32x32x16_bf16 v[48:63], v[114:117], v[100:103], v[48:63]
    v_smfmac_f32_32x32x32_bf16 v[80:95], v[120:123], v[16:23], v136
    v_smfmac_f32_32x32x32_bf16 v[80:95], v[124:127], v[24:31], v136
    s_nop 7
    s_setprio 0
    v_exp_f32 v32, v32
    v_exp_f32 v33, v33
    v_exp_f32 v34, v34
    v_exp_f32 v35, v35
    v_exp_f32 v36, v36
    v_exp_f32 v37, v37
    v_exp_f32 v38, v38
    v_exp_f32 v39, v39
    v_exp_f32 v40, v40
    v_exp_f32 v41, v41
    v_exp_f32 v42, v42
    v_exp_f32 v43, v43
    v_exp_f32 v44, v44
    v_exp_f32 v45, v45
    v_exp_f32 v46, v46
    v_exp_f32 v47, v47
    v_exp_f32 v48, v48
    s_setprio 2
    v_exp_f32 v49, v49
    v_exp_f32 v50, v50
    v_exp_f32 v51, v51
    v_exp_f32 v52, v52
    v_exp_f32 v53, v53
    v_exp_f32 v54, v54
    v_exp_f32 v55, v55
    v_exp_f32 v56, v56
    v_exp_f32 v57, v57
    v_exp_f32 v58, v58
    v_exp_f32 v59, v59
    v_exp_f32 v60, v60
    v_exp_f32 v61, v61
    v_exp_f32 v62, v62
    v_exp_f32 v63, v63
    s_setprio 3
    s_waitcnt lgkmcnt(0)
    v_mfma_f32_32x32x4_2b_bf16 v[0:31], v[118:119], v[104:105], 4.0 cbsz:1 abid:0
    ds_read_b64 v[114:115], v137 offset:49920
    ds_read_b64 v[116:117], v137 offset:49928
    v_smfmac_f32_32x32x32_bf16 v[64:79], v[128:131], v[32:39], v136
    ds_read_b64_tr_b16 v[120:121], v145 offset:7680
    ds_read_b64_tr_b16 v[122:123], v145 offset:7840
    s_nop 4
    v_smfmac_f32_32x32x32_bf16 v[64:79], v[132:135], v[40:47], v136
    ds_read_b64_tr_b16 v[124:125], v145 offset:8320
    ds_read_b64_tr_b16 v[126:127], v145 offset:8480
    s_nop 4
    v_mfma_f32_32x32x16_bf16 v[0:15], v[108:111], v[96:99], v[0:15]
    v_mfma_f32_32x32x16_bf16 v[16:31], v[108:111], v[100:103], v[16:31]
    v_smfmac_f32_32x32x32_bf16 v[80:95], v[128:131], v[48:55], v136
    v_smfmac_f32_32x32x32_bf16 v[80:95], v[132:135], v[56:63], v136
    s_nop 7
    s_setprio 0
    v_exp_f32 v0, v0
    v_exp_f32 v1, v1
    v_exp_f32 v2, v2
    v_exp_f32 v3, v3
    v_exp_f32 v4, v4
    v_exp_f32 v5, v5
    v_exp_f32 v6, v6
    v_exp_f32 v7, v7
    v_exp_f32 v8, v8
    v_exp_f32 v9, v9
    v_exp_f32 v10, v10
    v_exp_f32 v11, v11
    v_exp_f32 v12, v12
    v_exp_f32 v13, v13
    v_exp_f32 v14, v14
    v_exp_f32 v15, v15
    v_exp_f32 v16, v16
    s_setprio 2
    v_exp_f32 v17, v17
    v_exp_f32 v18, v18
    v_exp_f32 v19, v19
    v_exp_f32 v20, v20
    v_exp_f32 v21, v21
    v_exp_f32 v22, v22
    v_exp_f32 v23, v23
    v_exp_f32 v24, v24
    v_exp_f32 v25, v25
    v_exp_f32 v26, v26
    v_exp_f32 v27, v27
    v_exp_f32 v28, v28
    v_exp_f32 v29, v29
    v_exp_f32 v30, v30
    v_exp_f32 v31, v31
    s_setprio 3
    s_waitcnt lgkmcnt(0)
    v_mfma_f32_32x32x4_2b_bf16 v[32:63], v[118:119], v[104:105], 4.0 cbsz:1 abid:1
    ds_read_b64 v[112:113], v139 offset:51200
    ds_read_b64 v[108:109], v137 offset:51200
    ds_read_b64 v[110:111], v137 offset:51208
    v_smfmac_f32_32x32x32_bf16 v[64:79], v[120:123], v[0:7], v136
    ds_read_b64_tr_b16 v[128:129], v145 offset:8960
    ds_read_b64_tr_b16 v[130:131], v145 offset:9120
    s_nop 3
    v_smfmac_f32_32x32x32_bf16 v[64:79], v[124:127], v[8:15], v136
    ds_read_b64_tr_b16 v[132:133], v145 offset:9600
    ds_read_b64_tr_b16 v[134:135], v145 offset:9760
    s_nop 4
    v_mfma_f32_32x32x16_bf16 v[32:47], v[114:117], v[96:99], v[32:47]
    v_mfma_f32_32x32x16_bf16 v[48:63], v[114:117], v[100:103], v[48:63]
    v_smfmac_f32_32x32x32_bf16 v[80:95], v[120:123], v[16:23], v136
    v_smfmac_f32_32x32x32_bf16 v[80:95], v[124:127], v[24:31], v136
    s_nop 7
    s_setprio 0
    v_exp_f32 v32, v32
    v_exp_f32 v33, v33
    v_exp_f32 v34, v34
    v_exp_f32 v35, v35
    v_exp_f32 v36, v36
    v_exp_f32 v37, v37
    v_exp_f32 v38, v38
    v_exp_f32 v39, v39
    v_exp_f32 v40, v40
    v_exp_f32 v41, v41
    v_exp_f32 v42, v42
    v_exp_f32 v43, v43
    v_exp_f32 v44, v44
    v_exp_f32 v45, v45
    v_exp_f32 v46, v46
    v_exp_f32 v47, v47
    v_exp_f32 v48, v48
    s_setprio 2
    v_exp_f32 v49, v49
    v_exp_f32 v50, v50
    v_exp_f32 v51, v51
    v_exp_f32 v52, v52
    v_exp_f32 v53, v53
    v_exp_f32 v54, v54
    v_exp_f32 v55, v55
    v_exp_f32 v56, v56
    v_exp_f32 v57, v57
    v_exp_f32 v58, v58
    v_exp_f32 v59, v59
    v_exp_f32 v60, v60
    v_exp_f32 v61, v61
    v_exp_f32 v62, v62
    v_exp_f32 v63, v63
    s_setprio 3
    s_waitcnt lgkmcnt(0)
    v_mfma_f32_32x32x4_2b_bf16 v[0:31], v[112:113], v[104:105], 4.0 cbsz:1 abid:0
    ds_read_b64 v[114:115], v137 offset:52480
    ds_read_b64 v[116:117], v137 offset:52488
    v_smfmac_f32_32x32x32_bf16 v[64:79], v[128:131], v[32:39], v136
    ds_read_b64_tr_b16 v[120:121], v146 offset:0
    ds_read_b64_tr_b16 v[122:123], v146 offset:160
    s_nop 4
    v_smfmac_f32_32x32x32_bf16 v[64:79], v[132:135], v[40:47], v136
    ds_read_b64_tr_b16 v[124:125], v146 offset:640
    ds_read_b64_tr_b16 v[126:127], v146 offset:800
    s_nop 4
    v_mfma_f32_32x32x16_bf16 v[0:15], v[108:111], v[96:99], v[0:15]
    v_mfma_f32_32x32x16_bf16 v[16:31], v[108:111], v[100:103], v[16:31]
    v_smfmac_f32_32x32x32_bf16 v[80:95], v[128:131], v[48:55], v136
    v_smfmac_f32_32x32x32_bf16 v[80:95], v[132:135], v[56:63], v136
    s_nop 7
    s_setprio 0
    v_exp_f32 v0, v0
    v_exp_f32 v1, v1
    v_exp_f32 v2, v2
    v_exp_f32 v3, v3
    v_exp_f32 v4, v4
    v_exp_f32 v5, v5
    v_exp_f32 v6, v6
    v_exp_f32 v7, v7
    v_exp_f32 v8, v8
    v_exp_f32 v9, v9
    v_exp_f32 v10, v10
    v_exp_f32 v11, v11
    v_exp_f32 v12, v12
    v_exp_f32 v13, v13
    v_exp_f32 v14, v14
    v_exp_f32 v15, v15
    v_exp_f32 v16, v16
    s_setprio 2
    v_exp_f32 v17, v17
    v_exp_f32 v18, v18
    v_exp_f32 v19, v19
    v_exp_f32 v20, v20
    v_exp_f32 v21, v21
    v_exp_f32 v22, v22
    v_exp_f32 v23, v23
    v_exp_f32 v24, v24
    v_exp_f32 v25, v25
    v_exp_f32 v26, v26
    v_exp_f32 v27, v27
    v_exp_f32 v28, v28
    v_exp_f32 v29, v29
    v_exp_f32 v30, v30
    v_exp_f32 v31, v31
    s_setprio 3
    s_waitcnt lgkmcnt(0)
    v_mfma_f32_32x32x4_2b_bf16 v[32:63], v[112:113], v[104:105], 4.0 cbsz:1 abid:1
    ds_read_b64 v[118:119], v139 offset:53760
    ds_read_b64 v[108:109], v137 offset:53760
    ds_read_b64 v[110:111], v137 offset:53768
    v_smfmac_f32_32x32x32_bf16 v[64:79], v[120:123], v[0:7], v136
    ds_read_b64_tr_b16 v[128:129], v146 offset:1280
    ds_read_b64_tr_b16 v[130:131], v146 offset:1440
    s_nop 3
    v_smfmac_f32_32x32x32_bf16 v[64:79], v[124:127], v[8:15], v136
    ds_read_b64_tr_b16 v[132:133], v146 offset:1920
    ds_read_b64_tr_b16 v[134:135], v146 offset:2080
    s_nop 4
    v_mfma_f32_32x32x16_bf16 v[32:47], v[114:117], v[96:99], v[32:47]
    v_mfma_f32_32x32x16_bf16 v[48:63], v[114:117], v[100:103], v[48:63]
    v_smfmac_f32_32x32x32_bf16 v[80:95], v[120:123], v[16:23], v136
    v_smfmac_f32_32x32x32_bf16 v[80:95], v[124:127], v[24:31], v136
    s_nop 7
    s_setprio 0
    v_exp_f32 v32, v32
    v_exp_f32 v33, v33
    v_exp_f32 v34, v34
    v_exp_f32 v35, v35
    v_exp_f32 v36, v36
    v_exp_f32 v37, v37
    v_exp_f32 v38, v38
    v_exp_f32 v39, v39
    v_exp_f32 v40, v40
    v_exp_f32 v41, v41
    v_exp_f32 v42, v42
    v_exp_f32 v43, v43
    v_exp_f32 v44, v44
    v_exp_f32 v45, v45
    v_exp_f32 v46, v46
    v_exp_f32 v47, v47
    v_exp_f32 v48, v48
    s_setprio 2
    v_exp_f32 v49, v49
    v_exp_f32 v50, v50
    v_exp_f32 v51, v51
    v_exp_f32 v52, v52
    v_exp_f32 v53, v53
    v_exp_f32 v54, v54
    v_exp_f32 v55, v55
    v_exp_f32 v56, v56
    v_exp_f32 v57, v57
    v_exp_f32 v58, v58
    v_exp_f32 v59, v59
    v_exp_f32 v60, v60
    v_exp_f32 v61, v61
    v_exp_f32 v62, v62
    v_exp_f32 v63, v63
    s_setprio 3
    s_waitcnt lgkmcnt(0)
    v_mfma_f32_32x32x4_2b_bf16 v[0:31], v[118:119], v[104:105], 4.0 cbsz:1 abid:0
    ds_read_b64 v[114:115], v137 offset:55040
    ds_read_b64 v[116:117], v137 offset:55048
    v_smfmac_f32_32x32x32_bf16 v[64:79], v[128:131], v[32:39], v136
    ds_read_b64_tr_b16 v[120:121], v146 offset:2560
    ds_read_b64_tr_b16 v[122:123], v146 offset:2720
    s_nop 4
    v_smfmac_f32_32x32x32_bf16 v[64:79], v[132:135], v[40:47], v136
    ds_read_b64_tr_b16 v[124:125], v146 offset:3200
    ds_read_b64_tr_b16 v[126:127], v146 offset:3360
    s_nop 4
    v_mfma_f32_32x32x16_bf16 v[0:15], v[108:111], v[96:99], v[0:15]
    v_mfma_f32_32x32x16_bf16 v[16:31], v[108:111], v[100:103], v[16:31]
    v_smfmac_f32_32x32x32_bf16 v[80:95], v[128:131], v[48:55], v136
    v_smfmac_f32_32x32x32_bf16 v[80:95], v[132:135], v[56:63], v136
    s_nop 7
    s_setprio 0
    v_exp_f32 v0, v0
    v_exp_f32 v1, v1
    v_exp_f32 v2, v2
    v_exp_f32 v3, v3
    v_exp_f32 v4, v4
    v_exp_f32 v5, v5
    v_exp_f32 v6, v6
    v_exp_f32 v7, v7
    v_exp_f32 v8, v8
    v_exp_f32 v9, v9
    v_exp_f32 v10, v10
    v_exp_f32 v11, v11
    v_exp_f32 v12, v12
    v_exp_f32 v13, v13
    v_exp_f32 v14, v14
    v_exp_f32 v15, v15
    v_exp_f32 v16, v16
    s_setprio 2
    v_exp_f32 v17, v17
    v_exp_f32 v18, v18
    v_exp_f32 v19, v19
    v_exp_f32 v20, v20
    v_exp_f32 v21, v21
    v_exp_f32 v22, v22
    v_exp_f32 v23, v23
    v_exp_f32 v24, v24
    v_exp_f32 v25, v25
    v_exp_f32 v26, v26
    v_exp_f32 v27, v27
    v_exp_f32 v28, v28
    v_exp_f32 v29, v29
    v_exp_f32 v30, v30
    v_exp_f32 v31, v31
    s_setprio 3
    s_waitcnt lgkmcnt(0)
    v_mfma_f32_32x32x4_2b_bf16 v[32:63], v[118:119], v[104:105], 4.0 cbsz:1 abid:1
    ds_read_b64 v[112:113], v139 offset:56320
    ds_read_b64 v[108:109], v137 offset:56320
    ds_read_b64 v[110:111], v137 offset:56328
    v_smfmac_f32_32x32x32_bf16 v[64:79], v[120:123], v[0:7], v136
    ds_read_b64_tr_b16 v[128:129], v146 offset:3840
    ds_read_b64_tr_b16 v[130:131], v146 offset:4000
    s_nop 3
    v_smfmac_f32_32x32x32_bf16 v[64:79], v[124:127], v[8:15], v136
    ds_read_b64_tr_b16 v[132:133], v146 offset:4480
    ds_read_b64_tr_b16 v[134:135], v146 offset:4640
    s_nop 4
    v_mfma_f32_32x32x16_bf16 v[32:47], v[114:117], v[96:99], v[32:47]
    v_mfma_f32_32x32x16_bf16 v[48:63], v[114:117], v[100:103], v[48:63]
    v_smfmac_f32_32x32x32_bf16 v[80:95], v[120:123], v[16:23], v136
    v_smfmac_f32_32x32x32_bf16 v[80:95], v[124:127], v[24:31], v136
    s_nop 7
    s_setprio 0
    v_exp_f32 v32, v32
    v_exp_f32 v33, v33
    v_exp_f32 v34, v34
    v_exp_f32 v35, v35
    v_exp_f32 v36, v36
    v_exp_f32 v37, v37
    v_exp_f32 v38, v38
    v_exp_f32 v39, v39
    v_exp_f32 v40, v40
    v_exp_f32 v41, v41
    v_exp_f32 v42, v42
    v_exp_f32 v43, v43
    v_exp_f32 v44, v44
    v_exp_f32 v45, v45
    v_exp_f32 v46, v46
    v_exp_f32 v47, v47
    v_exp_f32 v48, v48
    s_setprio 2
    v_exp_f32 v49, v49
    v_exp_f32 v50, v50
    v_exp_f32 v51, v51
    v_exp_f32 v52, v52
    v_exp_f32 v53, v53
    v_exp_f32 v54, v54
    v_exp_f32 v55, v55
    v_exp_f32 v56, v56
    v_exp_f32 v57, v57
    v_exp_f32 v58, v58
    v_exp_f32 v59, v59
    v_exp_f32 v60, v60
    v_exp_f32 v61, v61
    v_exp_f32 v62, v62
    v_exp_f32 v63, v63
    s_setprio 3
    s_waitcnt lgkmcnt(0)
    v_mfma_f32_32x32x4_2b_bf16 v[0:31], v[112:113], v[104:105], 4.0 cbsz:1 abid:0
    ds_read_b64 v[114:115], v137 offset:57600
    ds_read_b64 v[116:117], v137 offset:57608
    v_smfmac_f32_32x32x32_bf16 v[64:79], v[128:131], v[32:39], v136
    ds_read_b64_tr_b16 v[120:121], v146 offset:5120
    ds_read_b64_tr_b16 v[122:123], v146 offset:5280
    s_nop 4
    v_smfmac_f32_32x32x32_bf16 v[64:79], v[132:135], v[40:47], v136
    ds_read_b64_tr_b16 v[124:125], v146 offset:5760
    ds_read_b64_tr_b16 v[126:127], v146 offset:5920
    s_nop 4
    v_mfma_f32_32x32x16_bf16 v[0:15], v[108:111], v[96:99], v[0:15]
    v_mfma_f32_32x32x16_bf16 v[16:31], v[108:111], v[100:103], v[16:31]
    v_smfmac_f32_32x32x32_bf16 v[80:95], v[128:131], v[48:55], v136
    v_smfmac_f32_32x32x32_bf16 v[80:95], v[132:135], v[56:63], v136
    s_nop 7
    s_setprio 0
    v_exp_f32 v0, v0
    v_exp_f32 v1, v1
    v_exp_f32 v2, v2
    v_exp_f32 v3, v3
    v_exp_f32 v4, v4
    v_exp_f32 v5, v5
    v_exp_f32 v6, v6
    v_exp_f32 v7, v7
    v_exp_f32 v8, v8
    v_exp_f32 v9, v9
    v_exp_f32 v10, v10
    v_exp_f32 v11, v11
    v_exp_f32 v12, v12
    v_exp_f32 v13, v13
    v_exp_f32 v14, v14
    v_exp_f32 v15, v15
    v_exp_f32 v16, v16
    s_setprio 2
    v_exp_f32 v17, v17
    v_exp_f32 v18, v18
    v_exp_f32 v19, v19
    v_exp_f32 v20, v20
    v_exp_f32 v21, v21
    v_exp_f32 v22, v22
    v_exp_f32 v23, v23
    v_exp_f32 v24, v24
    v_exp_f32 v25, v25
    v_exp_f32 v26, v26
    v_exp_f32 v27, v27
    v_exp_f32 v28, v28
    v_exp_f32 v29, v29
    v_exp_f32 v30, v30
    v_exp_f32 v31, v31
    s_setprio 3
    s_waitcnt lgkmcnt(0)
    v_mfma_f32_32x32x4_2b_bf16 v[32:63], v[112:113], v[104:105], 4.0 cbsz:1 abid:1
    ds_read_b64 v[118:119], v139 offset:58880
    ds_read_b64 v[108:109], v137 offset:58880
    ds_read_b64 v[110:111], v137 offset:58888
    v_smfmac_f32_32x32x32_bf16 v[64:79], v[120:123], v[0:7], v136
    ds_read_b64_tr_b16 v[128:129], v146 offset:6400
    ds_read_b64_tr_b16 v[130:131], v146 offset:6560
    s_nop 3
    v_smfmac_f32_32x32x32_bf16 v[64:79], v[124:127], v[8:15], v136
    ds_read_b64_tr_b16 v[132:133], v146 offset:7040
    ds_read_b64_tr_b16 v[134:135], v146 offset:7200
    s_nop 4
    v_mfma_f32_32x32x16_bf16 v[32:47], v[114:117], v[96:99], v[32:47]
    v_mfma_f32_32x32x16_bf16 v[48:63], v[114:117], v[100:103], v[48:63]
    v_smfmac_f32_32x32x32_bf16 v[80:95], v[120:123], v[16:23], v136
    v_smfmac_f32_32x32x32_bf16 v[80:95], v[124:127], v[24:31], v136
    s_nop 7
    s_setprio 0
    v_exp_f32 v32, v32
    v_exp_f32 v33, v33
    v_exp_f32 v34, v34
    v_exp_f32 v35, v35
    v_exp_f32 v36, v36
    v_exp_f32 v37, v37
    v_exp_f32 v38, v38
    v_exp_f32 v39, v39
    v_exp_f32 v40, v40
    v_exp_f32 v41, v41
    v_exp_f32 v42, v42
    v_exp_f32 v43, v43
    v_exp_f32 v44, v44
    v_exp_f32 v45, v45
    v_exp_f32 v46, v46
    v_exp_f32 v47, v47
    v_exp_f32 v48, v48
    s_setprio 2
    v_exp_f32 v49, v49
    v_exp_f32 v50, v50
    v_exp_f32 v51, v51
    v_exp_f32 v52, v52
    v_exp_f32 v53, v53
    v_exp_f32 v54, v54
    v_exp_f32 v55, v55
    v_exp_f32 v56, v56
    v_exp_f32 v57, v57
    v_exp_f32 v58, v58
    v_exp_f32 v59, v59
    v_exp_f32 v60, v60
    v_exp_f32 v61, v61
    v_exp_f32 v62, v62
    v_exp_f32 v63, v63
    s_setprio 3
    s_waitcnt lgkmcnt(0)
    v_mfma_f32_32x32x4_2b_bf16 v[0:31], v[118:119], v[104:105], 4.0 cbsz:1 abid:0
    ds_read_b64 v[114:115], v137 offset:60160
    ds_read_b64 v[116:117], v137 offset:60168
    v_smfmac_f32_32x32x32_bf16 v[64:79], v[128:131], v[32:39], v136
    ds_read_b64_tr_b16 v[120:121], v146 offset:7680
    ds_read_b64_tr_b16 v[122:123], v146 offset:7840
    s_nop 4
    v_smfmac_f32_32x32x32_bf16 v[64:79], v[132:135], v[40:47], v136
    ds_read_b64_tr_b16 v[124:125], v146 offset:8320
    ds_read_b64_tr_b16 v[126:127], v146 offset:8480
    s_nop 4
    v_mfma_f32_32x32x16_bf16 v[0:15], v[108:111], v[96:99], v[0:15]
    v_mfma_f32_32x32x16_bf16 v[16:31], v[108:111], v[100:103], v[16:31]
    v_smfmac_f32_32x32x32_bf16 v[80:95], v[128:131], v[48:55], v136
    v_smfmac_f32_32x32x32_bf16 v[80:95], v[132:135], v[56:63], v136
    s_nop 7
    s_setprio 0
    v_exp_f32 v0, v0
    v_exp_f32 v1, v1
    v_exp_f32 v2, v2
    v_exp_f32 v3, v3
    v_exp_f32 v4, v4
    v_exp_f32 v5, v5
    v_exp_f32 v6, v6
    v_exp_f32 v7, v7
    v_exp_f32 v8, v8
    v_exp_f32 v9, v9
    v_exp_f32 v10, v10
    v_exp_f32 v11, v11
    v_exp_f32 v12, v12
    v_exp_f32 v13, v13
    v_exp_f32 v14, v14
    v_exp_f32 v15, v15
    v_exp_f32 v16, v16
    s_setprio 2
    v_exp_f32 v17, v17
    v_exp_f32 v18, v18
    v_exp_f32 v19, v19
    v_exp_f32 v20, v20
    v_exp_f32 v21, v21
    v_exp_f32 v22, v22
    v_exp_f32 v23, v23
    v_exp_f32 v24, v24
    v_exp_f32 v25, v25
    v_exp_f32 v26, v26
    v_exp_f32 v27, v27
    v_exp_f32 v28, v28
    v_exp_f32 v29, v29
    v_exp_f32 v30, v30
    v_exp_f32 v31, v31
    s_setprio 3
    s_waitcnt lgkmcnt(0)
    v_mfma_f32_32x32x4_2b_bf16 v[32:63], v[118:119], v[104:105], 4.0 cbsz:1 abid:1
    ds_read_b64 v[112:113], v140 offset:0
    ds_read_b64 v[108:109], v138 offset:0
    ds_read_b64 v[110:111], v138 offset:8
    v_smfmac_f32_32x32x32_bf16 v[64:79], v[120:123], v[0:7], v136
    ds_read_b64_tr_b16 v[128:129], v146 offset:8960
    ds_read_b64_tr_b16 v[130:131], v146 offset:9120
    s_nop 3
    v_smfmac_f32_32x32x32_bf16 v[64:79], v[124:127], v[8:15], v136
    ds_read_b64_tr_b16 v[132:133], v146 offset:9600
    ds_read_b64_tr_b16 v[134:135], v146 offset:9760
    s_nop 4
    v_mfma_f32_32x32x16_bf16 v[32:47], v[114:117], v[96:99], v[32:47]
    v_mfma_f32_32x32x16_bf16 v[48:63], v[114:117], v[100:103], v[48:63]
    v_smfmac_f32_32x32x32_bf16 v[80:95], v[120:123], v[16:23], v136
    v_smfmac_f32_32x32x32_bf16 v[80:95], v[124:127], v[24:31], v136
    s_nop 7
    s_setprio 0
    v_exp_f32 v32, v32
    v_exp_f32 v33, v33
    v_exp_f32 v34, v34
    v_exp_f32 v35, v35
    v_exp_f32 v36, v36
    v_exp_f32 v37, v37
    v_exp_f32 v38, v38
    v_exp_f32 v39, v39
    v_exp_f32 v40, v40
    v_exp_f32 v41, v41
    v_exp_f32 v42, v42
    v_exp_f32 v43, v43
    v_exp_f32 v44, v44
    v_exp_f32 v45, v45
    v_exp_f32 v46, v46
    v_exp_f32 v47, v47
    v_exp_f32 v48, v48
    s_setprio 2
    v_exp_f32 v49, v49
    v_exp_f32 v50, v50
    v_exp_f32 v51, v51
    v_exp_f32 v52, v52
    v_exp_f32 v53, v53
    v_exp_f32 v54, v54
    v_exp_f32 v55, v55
    v_exp_f32 v56, v56
    v_exp_f32 v57, v57
    v_exp_f32 v58, v58
    v_exp_f32 v59, v59
    v_exp_f32 v60, v60
    v_exp_f32 v61, v61
    v_exp_f32 v62, v62
    v_exp_f32 v63, v63
    s_setprio 3
    s_waitcnt lgkmcnt(0)
    v_mfma_f32_32x32x4_2b_bf16 v[0:31], v[112:113], v[104:105], 4.0 cbsz:1 abid:0
    ds_read_b64 v[114:115], v138 offset:1280
    ds_read_b64 v[116:117], v138 offset:1288
    v_smfmac_f32_32x32x32_bf16 v[64:79], v[128:131], v[32:39], v136
    ds_read_b64_tr_b16 v[120:121], v147 offset:0
    ds_read_b64_tr_b16 v[122:123], v147 offset:160
    s_nop 4
    v_smfmac_f32_32x32x32_bf16 v[64:79], v[132:135], v[40:47], v136
    ds_read_b64_tr_b16 v[124:125], v147 offset:640
    ds_read_b64_tr_b16 v[126:127], v147 offset:800
    s_nop 4
    v_mfma_f32_32x32x16_bf16 v[0:15], v[108:111], v[96:99], v[0:15]
    v_mfma_f32_32x32x16_bf16 v[16:31], v[108:111], v[100:103], v[16:31]
    v_smfmac_f32_32x32x32_bf16 v[80:95], v[128:131], v[48:55], v136
    v_smfmac_f32_32x32x32_bf16 v[80:95], v[132:135], v[56:63], v136
    s_nop 7
    s_setprio 0
    v_exp_f32 v0, v0
    v_exp_f32 v1, v1
    v_exp_f32 v2, v2
    v_exp_f32 v3, v3
    v_exp_f32 v4, v4
    v_exp_f32 v5, v5
    v_exp_f32 v6, v6
    v_exp_f32 v7, v7
    v_exp_f32 v8, v8
    v_exp_f32 v9, v9
    v_exp_f32 v10, v10
    v_exp_f32 v11, v11
    v_exp_f32 v12, v12
    v_exp_f32 v13, v13
    v_exp_f32 v14, v14
    v_exp_f32 v15, v15
    v_exp_f32 v16, v16
    s_setprio 2
    v_exp_f32 v17, v17
    v_exp_f32 v18, v18
    v_exp_f32 v19, v19
    v_exp_f32 v20, v20
    v_exp_f32 v21, v21
    v_exp_f32 v22, v22
    v_exp_f32 v23, v23
    v_exp_f32 v24, v24
    v_exp_f32 v25, v25
    v_exp_f32 v26, v26
    v_exp_f32 v27, v27
    v_exp_f32 v28, v28
    v_exp_f32 v29, v29
    v_exp_f32 v30, v30
    v_exp_f32 v31, v31
    s_setprio 3
    s_waitcnt lgkmcnt(0)
    v_mfma_f32_32x32x4_2b_bf16 v[32:63], v[112:113], v[104:105], 4.0 cbsz:1 abid:1
    ds_read_b64 v[118:119], v140 offset:2560
    ds_read_b64 v[108:109], v138 offset:2560
    ds_read_b64 v[110:111], v138 offset:2568
    v_smfmac_f32_32x32x32_bf16 v[64:79], v[120:123], v[0:7], v136
    ds_read_b64_tr_b16 v[128:129], v147 offset:1280
    ds_read_b64_tr_b16 v[130:131], v147 offset:1440
    s_nop 3
    v_smfmac_f32_32x32x32_bf16 v[64:79], v[124:127], v[8:15], v136
    ds_read_b64_tr_b16 v[132:133], v147 offset:1920
    ds_read_b64_tr_b16 v[134:135], v147 offset:2080
    s_nop 4
    v_mfma_f32_32x32x16_bf16 v[32:47], v[114:117], v[96:99], v[32:47]
    v_mfma_f32_32x32x16_bf16 v[48:63], v[114:117], v[100:103], v[48:63]
    v_smfmac_f32_32x32x32_bf16 v[80:95], v[120:123], v[16:23], v136
    v_smfmac_f32_32x32x32_bf16 v[80:95], v[124:127], v[24:31], v136
    s_nop 7
    s_setprio 0
    v_exp_f32 v32, v32
    v_exp_f32 v33, v33
    v_exp_f32 v34, v34
    v_exp_f32 v35, v35
    v_exp_f32 v36, v36
    v_exp_f32 v37, v37
    v_exp_f32 v38, v38
    v_exp_f32 v39, v39
    v_exp_f32 v40, v40
    v_exp_f32 v41, v41
    v_exp_f32 v42, v42
    v_exp_f32 v43, v43
    v_exp_f32 v44, v44
    v_exp_f32 v45, v45
    v_exp_f32 v46, v46
    v_exp_f32 v47, v47
    v_exp_f32 v48, v48
    s_setprio 2
    v_exp_f32 v49, v49
    v_exp_f32 v50, v50
    v_exp_f32 v51, v51
    v_exp_f32 v52, v52
    v_exp_f32 v53, v53
    v_exp_f32 v54, v54
    v_exp_f32 v55, v55
    v_exp_f32 v56, v56
    v_exp_f32 v57, v57
    v_exp_f32 v58, v58
    v_exp_f32 v59, v59
    v_exp_f32 v60, v60
    v_exp_f32 v61, v61
    v_exp_f32 v62, v62
    v_exp_f32 v63, v63
    s_setprio 3
    s_waitcnt lgkmcnt(0)
    v_mfma_f32_32x32x4_2b_bf16 v[0:31], v[118:119], v[104:105], 4.0 cbsz:1 abid:0
    ds_read_b64 v[114:115], v138 offset:3840
    ds_read_b64 v[116:117], v138 offset:3848
    v_smfmac_f32_32x32x32_bf16 v[64:79], v[128:131], v[32:39], v136
    ds_read_b64_tr_b16 v[120:121], v147 offset:2560
    ds_read_b64_tr_b16 v[122:123], v147 offset:2720
    s_nop 4
    v_smfmac_f32_32x32x32_bf16 v[64:79], v[132:135], v[40:47], v136
    ds_read_b64_tr_b16 v[124:125], v147 offset:3200
    ds_read_b64_tr_b16 v[126:127], v147 offset:3360
    s_nop 4
    v_mfma_f32_32x32x16_bf16 v[0:15], v[108:111], v[96:99], v[0:15]
    v_mfma_f32_32x32x16_bf16 v[16:31], v[108:111], v[100:103], v[16:31]
    v_smfmac_f32_32x32x32_bf16 v[80:95], v[128:131], v[48:55], v136
    v_smfmac_f32_32x32x32_bf16 v[80:95], v[132:135], v[56:63], v136
    s_nop 7
    s_setprio 0
    v_exp_f32 v0, v0
    v_exp_f32 v1, v1
    v_exp_f32 v2, v2
    v_exp_f32 v3, v3
    v_exp_f32 v4, v4
    v_exp_f32 v5, v5
    v_exp_f32 v6, v6
    v_exp_f32 v7, v7
    v_exp_f32 v8, v8
    v_exp_f32 v9, v9
    v_exp_f32 v10, v10
    v_exp_f32 v11, v11
    v_exp_f32 v12, v12
    v_exp_f32 v13, v13
    v_exp_f32 v14, v14
    v_exp_f32 v15, v15
    v_exp_f32 v16, v16
    s_setprio 2
    v_exp_f32 v17, v17
    v_exp_f32 v18, v18
    v_exp_f32 v19, v19
    v_exp_f32 v20, v20
    v_exp_f32 v21, v21
    v_exp_f32 v22, v22
    v_exp_f32 v23, v23
    v_exp_f32 v24, v24
    v_exp_f32 v25, v25
    v_exp_f32 v26, v26
    v_exp_f32 v27, v27
    v_exp_f32 v28, v28
    v_exp_f32 v29, v29
    v_exp_f32 v30, v30
    v_exp_f32 v31, v31
    s_setprio 3
    s_waitcnt lgkmcnt(0)
    v_mfma_f32_32x32x4_2b_bf16 v[32:63], v[118:119], v[104:105], 4.0 cbsz:1 abid:1
    ds_read_b64 v[112:113], v140 offset:5120
    ds_read_b64 v[108:109], v138 offset:5120
    ds_read_b64 v[110:111], v138 offset:5128
    v_smfmac_f32_32x32x32_bf16 v[64:79], v[120:123], v[0:7], v136
    ds_read_b64_tr_b16 v[128:129], v147 offset:3840
    ds_read_b64_tr_b16 v[130:131], v147 offset:4000
    s_nop 3
    v_smfmac_f32_32x32x32_bf16 v[64:79], v[124:127], v[8:15], v136
    ds_read_b64_tr_b16 v[132:133], v147 offset:4480
    ds_read_b64_tr_b16 v[134:135], v147 offset:4640
    s_nop 4
    v_mfma_f32_32x32x16_bf16 v[32:47], v[114:117], v[96:99], v[32:47]
    v_mfma_f32_32x32x16_bf16 v[48:63], v[114:117], v[100:103], v[48:63]
    v_smfmac_f32_32x32x32_bf16 v[80:95], v[120:123], v[16:23], v136
    v_smfmac_f32_32x32x32_bf16 v[80:95], v[124:127], v[24:31], v136
    s_nop 7
    s_setprio 0
    v_exp_f32 v32, v32
    v_exp_f32 v33, v33
    v_exp_f32 v34, v34
    v_exp_f32 v35, v35
    v_exp_f32 v36, v36
    v_exp_f32 v37, v37
    v_exp_f32 v38, v38
    v_exp_f32 v39, v39
    v_exp_f32 v40, v40
    v_exp_f32 v41, v41
    v_exp_f32 v42, v42
    v_exp_f32 v43, v43
    v_exp_f32 v44, v44
    v_exp_f32 v45, v45
    v_exp_f32 v46, v46
    v_exp_f32 v47, v47
    v_exp_f32 v48, v48
    s_setprio 2
    v_exp_f32 v49, v49
    v_exp_f32 v50, v50
    v_exp_f32 v51, v51
    v_exp_f32 v52, v52
    v_exp_f32 v53, v53
    v_exp_f32 v54, v54
    v_exp_f32 v55, v55
    v_exp_f32 v56, v56
    v_exp_f32 v57, v57
    v_exp_f32 v58, v58
    v_exp_f32 v59, v59
    v_exp_f32 v60, v60
    v_exp_f32 v61, v61
    v_exp_f32 v62, v62
    v_exp_f32 v63, v63
    s_setprio 3
    s_waitcnt lgkmcnt(0)
    v_mfma_f32_32x32x4_2b_bf16 v[0:31], v[112:113], v[104:105], 4.0 cbsz:1 abid:0
    ds_read_b64 v[114:115], v138 offset:6400
    ds_read_b64 v[116:117], v138 offset:6408
    v_smfmac_f32_32x32x32_bf16 v[64:79], v[128:131], v[32:39], v136
    ds_read_b64_tr_b16 v[120:121], v147 offset:5120
    ds_read_b64_tr_b16 v[122:123], v147 offset:5280
    s_nop 4
    v_smfmac_f32_32x32x32_bf16 v[64:79], v[132:135], v[40:47], v136
    ds_read_b64_tr_b16 v[124:125], v147 offset:5760
    ds_read_b64_tr_b16 v[126:127], v147 offset:5920
    s_nop 4
    v_mfma_f32_32x32x16_bf16 v[0:15], v[108:111], v[96:99], v[0:15]
    v_mfma_f32_32x32x16_bf16 v[16:31], v[108:111], v[100:103], v[16:31]
    v_smfmac_f32_32x32x32_bf16 v[80:95], v[128:131], v[48:55], v136
    v_smfmac_f32_32x32x32_bf16 v[80:95], v[132:135], v[56:63], v136
    s_nop 7
    s_setprio 0
    v_exp_f32 v0, v0
    v_exp_f32 v1, v1
    v_exp_f32 v2, v2
    v_exp_f32 v3, v3
    v_exp_f32 v4, v4
    v_exp_f32 v5, v5
    v_exp_f32 v6, v6
    v_exp_f32 v7, v7
    v_exp_f32 v8, v8
    v_exp_f32 v9, v9
    v_exp_f32 v10, v10
    v_exp_f32 v11, v11
    v_exp_f32 v12, v12
    v_exp_f32 v13, v13
    v_exp_f32 v14, v14
    v_exp_f32 v15, v15
    v_exp_f32 v16, v16
    s_setprio 2
    v_exp_f32 v17, v17
    v_exp_f32 v18, v18
    v_exp_f32 v19, v19
    v_exp_f32 v20, v20
    v_exp_f32 v21, v21
    v_exp_f32 v22, v22
    v_exp_f32 v23, v23
    v_exp_f32 v24, v24
    v_exp_f32 v25, v25
    v_exp_f32 v26, v26
    v_exp_f32 v27, v27
    v_exp_f32 v28, v28
    v_exp_f32 v29, v29
    v_exp_f32 v30, v30
    v_exp_f32 v31, v31
    s_setprio 3
    s_waitcnt lgkmcnt(0)
    v_mfma_f32_32x32x4_2b_bf16 v[32:63], v[112:113], v[104:105], 4.0 cbsz:1 abid:1
    ds_read_b64 v[118:119], v140 offset:7680
    ds_read_b64 v[108:109], v138 offset:7680
    ds_read_b64 v[110:111], v138 offset:7688
    v_smfmac_f32_32x32x32_bf16 v[64:79], v[120:123], v[0:7], v136
    ds_read_b64_tr_b16 v[128:129], v147 offset:6400
    ds_read_b64_tr_b16 v[130:131], v147 offset:6560
    s_nop 3
    v_smfmac_f32_32x32x32_bf16 v[64:79], v[124:127], v[8:15], v136
    ds_read_b64_tr_b16 v[132:133], v147 offset:7040
    ds_read_b64_tr_b16 v[134:135], v147 offset:7200
    s_nop 4
    v_mfma_f32_32x32x16_bf16 v[32:47], v[114:117], v[96:99], v[32:47]
    v_mfma_f32_32x32x16_bf16 v[48:63], v[114:117], v[100:103], v[48:63]
    v_smfmac_f32_32x32x32_bf16 v[80:95], v[120:123], v[16:23], v136
    v_smfmac_f32_32x32x32_bf16 v[80:95], v[124:127], v[24:31], v136
    s_nop 7
    s_setprio 0
    v_exp_f32 v32, v32
    v_exp_f32 v33, v33
    v_exp_f32 v34, v34
    v_exp_f32 v35, v35
    v_exp_f32 v36, v36
    v_exp_f32 v37, v37
    v_exp_f32 v38, v38
    v_exp_f32 v39, v39
    v_exp_f32 v40, v40
    v_exp_f32 v41, v41
    v_exp_f32 v42, v42
    v_exp_f32 v43, v43
    v_exp_f32 v44, v44
    v_exp_f32 v45, v45
    v_exp_f32 v46, v46
    v_exp_f32 v47, v47
    v_exp_f32 v48, v48
    s_setprio 2
    v_exp_f32 v49, v49
    v_exp_f32 v50, v50
    v_exp_f32 v51, v51
    v_exp_f32 v52, v52
    v_exp_f32 v53, v53
    v_exp_f32 v54, v54
    v_exp_f32 v55, v55
    v_exp_f32 v56, v56
    v_exp_f32 v57, v57
    v_exp_f32 v58, v58
    v_exp_f32 v59, v59
    v_exp_f32 v60, v60
    v_exp_f32 v61, v61
    v_exp_f32 v62, v62
    v_exp_f32 v63, v63
    s_setprio 3
    s_waitcnt lgkmcnt(0)
    v_mfma_f32_32x32x4_2b_bf16 v[0:31], v[118:119], v[104:105], 4.0 cbsz:1 abid:0
    ds_read_b64 v[114:115], v138 offset:8960
    ds_read_b64 v[116:117], v138 offset:8968
    v_smfmac_f32_32x32x32_bf16 v[64:79], v[128:131], v[32:39], v136
    ds_read_b64_tr_b16 v[120:121], v147 offset:7680
    ds_read_b64_tr_b16 v[122:123], v147 offset:7840
    s_nop 4
    v_smfmac_f32_32x32x32_bf16 v[64:79], v[132:135], v[40:47], v136
    ds_read_b64_tr_b16 v[124:125], v147 offset:8320
    ds_read_b64_tr_b16 v[126:127], v147 offset:8480
    s_nop 4
    v_mfma_f32_32x32x16_bf16 v[0:15], v[108:111], v[96:99], v[0:15]
    v_mfma_f32_32x32x16_bf16 v[16:31], v[108:111], v[100:103], v[16:31]
    v_smfmac_f32_32x32x32_bf16 v[80:95], v[128:131], v[48:55], v136
    v_smfmac_f32_32x32x32_bf16 v[80:95], v[132:135], v[56:63], v136
    s_nop 7
    s_setprio 0
    v_exp_f32 v0, v0
    v_exp_f32 v1, v1
    v_exp_f32 v2, v2
    v_exp_f32 v3, v3
    v_exp_f32 v4, v4
    v_exp_f32 v5, v5
    v_exp_f32 v6, v6
    v_exp_f32 v7, v7
    v_exp_f32 v8, v8
    v_exp_f32 v9, v9
    v_exp_f32 v10, v10
    v_exp_f32 v11, v11
    v_exp_f32 v12, v12
    v_exp_f32 v13, v13
    v_exp_f32 v14, v14
    v_exp_f32 v15, v15
    v_exp_f32 v16, v16
    s_setprio 2
    v_exp_f32 v17, v17
    v_exp_f32 v18, v18
    v_exp_f32 v19, v19
    v_exp_f32 v20, v20
    v_exp_f32 v21, v21
    v_exp_f32 v22, v22
    v_exp_f32 v23, v23
    v_exp_f32 v24, v24
    v_exp_f32 v25, v25
    v_exp_f32 v26, v26
    v_exp_f32 v27, v27
    v_exp_f32 v28, v28
    v_exp_f32 v29, v29
    v_exp_f32 v30, v30
    v_exp_f32 v31, v31
    s_setprio 3
    s_waitcnt vmcnt(0) lgkmcnt(0)
    s_barrier
    v_mfma_f32_32x32x4_2b_bf16 v[32:63], v[118:119], v[104:105], 4.0 cbsz:1 abid:1
    ds_read_b64 v[112:113], v139 offset:0
    ds_read_b64 v[108:109], v137 offset:0
    ds_read_b64 v[110:111], v137 offset:8
    v_smfmac_f32_32x32x32_bf16 v[64:79], v[120:123], v[0:7], v136
    ds_read_b64_tr_b16 v[128:129], v147 offset:8960
    ds_read_b64_tr_b16 v[130:131], v147 offset:9120
    s_nop 3
    v_smfmac_f32_32x32x32_bf16 v[64:79], v[124:127], v[8:15], v136
    ds_read_b64_tr_b16 v[132:133], v147 offset:9600
    ds_read_b64_tr_b16 v[134:135], v147 offset:9760
    s_nop 4
    v_mfma_f32_32x32x16_bf16 v[32:47], v[114:117], v[96:99], v[32:47]
    v_mfma_f32_32x32x16_bf16 v[48:63], v[114:117], v[100:103], v[48:63]
    v_smfmac_f32_32x32x32_bf16 v[80:95], v[120:123], v[16:23], v136
    v_smfmac_f32_32x32x32_bf16 v[80:95], v[124:127], v[24:31], v136
    s_nop 7
    s_setprio 0
    v_exp_f32 v32, v32
    v_exp_f32 v33, v33
    v_exp_f32 v34, v34
    v_exp_f32 v35, v35
    v_exp_f32 v36, v36
    v_exp_f32 v37, v37
    v_exp_f32 v38, v38
    v_exp_f32 v39, v39
    v_exp_f32 v40, v40
    v_exp_f32 v41, v41
    v_exp_f32 v42, v42
    v_exp_f32 v43, v43
    v_exp_f32 v44, v44
    v_exp_f32 v45, v45
    v_exp_f32 v46, v46
    v_exp_f32 v47, v47
    v_exp_f32 v48, v48
    s_setprio 2
    v_exp_f32 v49, v49
    v_exp_f32 v50, v50
    v_exp_f32 v51, v51
    v_exp_f32 v52, v52
    v_exp_f32 v53, v53
    v_exp_f32 v54, v54
    v_exp_f32 v55, v55
    v_exp_f32 v56, v56
    v_exp_f32 v57, v57
    v_exp_f32 v58, v58
    v_exp_f32 v59, v59
    v_exp_f32 v60, v60
    v_exp_f32 v61, v61
    v_exp_f32 v62, v62
    v_exp_f32 v63, v63
    s_setprio 3
    s_waitcnt lgkmcnt(0)
    v_mfma_f32_32x32x4_2b_bf16 v[0:31], v[112:113], v[104:105], 4.0 cbsz:1 abid:0
    ds_read_b64 v[114:115], v137 offset:1280
    ds_read_b64 v[116:117], v137 offset:1288
    v_smfmac_f32_32x32x32_bf16 v[64:79], v[128:131], v[32:39], v136
    ds_read_b64_tr_b16 v[120:121], v141 offset:0
    ds_read_b64_tr_b16 v[122:123], v141 offset:160
    s_nop 4
    v_smfmac_f32_32x32x32_bf16 v[64:79], v[132:135], v[40:47], v136
    ds_read_b64_tr_b16 v[124:125], v141 offset:640
    ds_read_b64_tr_b16 v[126:127], v141 offset:800
    s_nop 4
    v_mfma_f32_32x32x16_bf16 v[0:15], v[108:111], v[96:99], v[0:15]
    v_mfma_f32_32x32x16_bf16 v[16:31], v[108:111], v[100:103], v[16:31]
    v_smfmac_f32_32x32x32_bf16 v[80:95], v[128:131], v[48:55], v136
    v_smfmac_f32_32x32x32_bf16 v[80:95], v[132:135], v[56:63], v136
    s_nop 7
    s_setprio 0
    v_exp_f32 v0, v0
    v_exp_f32 v1, v1
    v_exp_f32 v2, v2
    v_exp_f32 v3, v3
    v_exp_f32 v4, v4
    v_exp_f32 v5, v5
    v_exp_f32 v6, v6
    v_exp_f32 v7, v7
    v_exp_f32 v8, v8
    v_exp_f32 v9, v9
    v_exp_f32 v10, v10
    v_exp_f32 v11, v11
    v_exp_f32 v12, v12
    v_exp_f32 v13, v13
    v_exp_f32 v14, v14
    v_exp_f32 v15, v15
    v_exp_f32 v16, v16
    s_setprio 2
    v_exp_f32 v17, v17
    v_exp_f32 v18, v18
    v_exp_f32 v19, v19
    v_exp_f32 v20, v20
    v_exp_f32 v21, v21
    v_exp_f32 v22, v22
    v_exp_f32 v23, v23
    v_exp_f32 v24, v24
    v_exp_f32 v25, v25
    v_exp_f32 v26, v26
    v_exp_f32 v27, v27
    v_exp_f32 v28, v28
    v_exp_f32 v29, v29
    v_exp_f32 v30, v30
    v_exp_f32 v31, v31
    s_setprio 3
    s_waitcnt lgkmcnt(0)
    v_mfma_f32_32x32x4_2b_bf16 v[32:63], v[112:113], v[104:105], 4.0 cbsz:1 abid:1
    ds_read_b64 v[118:119], v139 offset:2560
    ds_read_b64 v[108:109], v137 offset:2560
    ds_read_b64 v[110:111], v137 offset:2568
    v_smfmac_f32_32x32x32_bf16 v[64:79], v[120:123], v[0:7], v136
    ds_read_b64_tr_b16 v[128:129], v141 offset:1280
    ds_read_b64_tr_b16 v[130:131], v141 offset:1440
    s_nop 3
    v_smfmac_f32_32x32x32_bf16 v[64:79], v[124:127], v[8:15], v136
    ds_read_b64_tr_b16 v[132:133], v141 offset:1920
    ds_read_b64_tr_b16 v[134:135], v141 offset:2080
    s_nop 4
    v_mfma_f32_32x32x16_bf16 v[32:47], v[114:117], v[96:99], v[32:47]
    v_mfma_f32_32x32x16_bf16 v[48:63], v[114:117], v[100:103], v[48:63]
    v_smfmac_f32_32x32x32_bf16 v[80:95], v[120:123], v[16:23], v136
    v_smfmac_f32_32x32x32_bf16 v[80:95], v[124:127], v[24:31], v136
    s_nop 7
    s_setprio 0
    v_exp_f32 v32, v32
    v_exp_f32 v33, v33
    v_exp_f32 v34, v34
    v_exp_f32 v35, v35
    v_exp_f32 v36, v36
    v_exp_f32 v37, v37
    v_exp_f32 v38, v38
    v_exp_f32 v39, v39
    v_exp_f32 v40, v40
    v_exp_f32 v41, v41
    v_exp_f32 v42, v42
    v_exp_f32 v43, v43
    v_exp_f32 v44, v44
    v_exp_f32 v45, v45
    v_exp_f32 v46, v46
    v_exp_f32 v47, v47
    v_exp_f32 v48, v48
    s_setprio 2
    v_exp_f32 v49, v49
    v_exp_f32 v50, v50
    v_exp_f32 v51, v51
    v_exp_f32 v52, v52
    v_exp_f32 v53, v53
    v_exp_f32 v54, v54
    v_exp_f32 v55, v55
    v_exp_f32 v56, v56
    v_exp_f32 v57, v57
    v_exp_f32 v58, v58
    v_exp_f32 v59, v59
    v_exp_f32 v60, v60
    v_exp_f32 v61, v61
    v_exp_f32 v62, v62
    v_exp_f32 v63, v63
    s_setprio 3
    s_waitcnt lgkmcnt(0)
    v_mfma_f32_32x32x4_2b_bf16 v[0:31], v[118:119], v[104:105], 4.0 cbsz:1 abid:0
    ds_read_b64 v[114:115], v137 offset:3840
    ds_read_b64 v[116:117], v137 offset:3848
    v_smfmac_f32_32x32x32_bf16 v[64:79], v[128:131], v[32:39], v136
    ds_read_b64_tr_b16 v[120:121], v141 offset:2560
    ds_read_b64_tr_b16 v[122:123], v141 offset:2720
    s_nop 4
    v_smfmac_f32_32x32x32_bf16 v[64:79], v[132:135], v[40:47], v136
    ds_read_b64_tr_b16 v[124:125], v141 offset:3200
    ds_read_b64_tr_b16 v[126:127], v141 offset:3360
    s_nop 4
    v_mfma_f32_32x32x16_bf16 v[0:15], v[108:111], v[96:99], v[0:15]
    v_mfma_f32_32x32x16_bf16 v[16:31], v[108:111], v[100:103], v[16:31]
    v_smfmac_f32_32x32x32_bf16 v[80:95], v[128:131], v[48:55], v136
    v_smfmac_f32_32x32x32_bf16 v[80:95], v[132:135], v[56:63], v136
    s_nop 7
    s_setprio 0
    v_exp_f32 v0, v0
    v_exp_f32 v1, v1
    v_exp_f32 v2, v2
    v_exp_f32 v3, v3
    v_exp_f32 v4, v4
    v_exp_f32 v5, v5
    v_exp_f32 v6, v6
    v_exp_f32 v7, v7
    v_exp_f32 v8, v8
    v_exp_f32 v9, v9
    v_exp_f32 v10, v10
    v_exp_f32 v11, v11
    v_exp_f32 v12, v12
    v_exp_f32 v13, v13
    v_exp_f32 v14, v14
    v_exp_f32 v15, v15
    v_exp_f32 v16, v16
    s_setprio 2
    v_exp_f32 v17, v17
    v_exp_f32 v18, v18
    v_exp_f32 v19, v19
    v_exp_f32 v20, v20
    v_exp_f32 v21, v21
    v_exp_f32 v22, v22
    v_exp_f32 v23, v23
    v_exp_f32 v24, v24
    v_exp_f32 v25, v25
    v_exp_f32 v26, v26
    v_exp_f32 v27, v27
    v_exp_f32 v28, v28
    v_exp_f32 v29, v29
    v_exp_f32 v30, v30
    v_exp_f32 v31, v31
    s_setprio 3
    s_waitcnt lgkmcnt(0)
    v_mfma_f32_32x32x4_2b_bf16 v[32:63], v[118:119], v[104:105], 4.0 cbsz:1 abid:1
    ds_read_b64 v[112:113], v139 offset:5120
    ds_read_b64 v[108:109], v137 offset:5120
    ds_read_b64 v[110:111], v137 offset:5128
    v_smfmac_f32_32x32x32_bf16 v[64:79], v[120:123], v[0:7], v136
    ds_read_b64_tr_b16 v[128:129], v141 offset:3840
    ds_read_b64_tr_b16 v[130:131], v141 offset:4000
    s_nop 3
    v_smfmac_f32_32x32x32_bf16 v[64:79], v[124:127], v[8:15], v136
    ds_read_b64_tr_b16 v[132:133], v141 offset:4480
    ds_read_b64_tr_b16 v[134:135], v141 offset:4640
    s_nop 4
    v_mfma_f32_32x32x16_bf16 v[32:47], v[114:117], v[96:99], v[32:47]
    v_mfma_f32_32x32x16_bf16 v[48:63], v[114:117], v[100:103], v[48:63]
    v_smfmac_f32_32x32x32_bf16 v[80:95], v[120:123], v[16:23], v136
    v_smfmac_f32_32x32x32_bf16 v[80:95], v[124:127], v[24:31], v136
    s_nop 7
    s_setprio 0
    v_exp_f32 v32, v32
    v_exp_f32 v33, v33
    v_exp_f32 v34, v34
    v_exp_f32 v35, v35
    v_exp_f32 v36, v36
    v_exp_f32 v37, v37
    v_exp_f32 v38, v38
    v_exp_f32 v39, v39
    v_exp_f32 v40, v40
    v_exp_f32 v41, v41
    v_exp_f32 v42, v42
    v_exp_f32 v43, v43
    v_exp_f32 v44, v44
    v_exp_f32 v45, v45
    v_exp_f32 v46, v46
    v_exp_f32 v47, v47
    v_exp_f32 v48, v48
    s_setprio 2
    v_exp_f32 v49, v49
    v_exp_f32 v50, v50
    v_exp_f32 v51, v51
    v_exp_f32 v52, v52
    v_exp_f32 v53, v53
    v_exp_f32 v54, v54
    v_exp_f32 v55, v55
    v_exp_f32 v56, v56
    v_exp_f32 v57, v57
    v_exp_f32 v58, v58
    v_exp_f32 v59, v59
    v_exp_f32 v60, v60
    v_exp_f32 v61, v61
    v_exp_f32 v62, v62
    v_exp_f32 v63, v63
    s_setprio 3
    s_waitcnt lgkmcnt(0)
    v_mfma_f32_32x32x4_2b_bf16 v[0:31], v[112:113], v[104:105], 4.0 cbsz:1 abid:0
    ds_read_b64 v[114:115], v137 offset:6400
    ds_read_b64 v[116:117], v137 offset:6408
    v_smfmac_f32_32x32x32_bf16 v[64:79], v[128:131], v[32:39], v136
    ds_read_b64_tr_b16 v[120:121], v141 offset:5120
    ds_read_b64_tr_b16 v[122:123], v141 offset:5280
    s_nop 4
    v_smfmac_f32_32x32x32_bf16 v[64:79], v[132:135], v[40:47], v136
    ds_read_b64_tr_b16 v[124:125], v141 offset:5760
    ds_read_b64_tr_b16 v[126:127], v141 offset:5920
    s_nop 4
    v_mfma_f32_32x32x16_bf16 v[0:15], v[108:111], v[96:99], v[0:15]
    v_mfma_f32_32x32x16_bf16 v[16:31], v[108:111], v[100:103], v[16:31]
    v_smfmac_f32_32x32x32_bf16 v[80:95], v[128:131], v[48:55], v136
    v_smfmac_f32_32x32x32_bf16 v[80:95], v[132:135], v[56:63], v136
    s_nop 7
    s_setprio 0
    v_exp_f32 v0, v0
    v_exp_f32 v1, v1
    v_exp_f32 v2, v2
    v_exp_f32 v3, v3
    v_exp_f32 v4, v4
    v_exp_f32 v5, v5
    v_exp_f32 v6, v6
    v_exp_f32 v7, v7
    v_exp_f32 v8, v8
    v_exp_f32 v9, v9
    v_exp_f32 v10, v10
    v_exp_f32 v11, v11
    v_exp_f32 v12, v12
    v_exp_f32 v13, v13
    v_exp_f32 v14, v14
    v_exp_f32 v15, v15
    v_exp_f32 v16, v16
    s_setprio 2
    v_exp_f32 v17, v17
    v_exp_f32 v18, v18
    v_exp_f32 v19, v19
    v_exp_f32 v20, v20
    v_exp_f32 v21, v21
    v_exp_f32 v22, v22
    v_exp_f32 v23, v23
    v_exp_f32 v24, v24
    v_exp_f32 v25, v25
    v_exp_f32 v26, v26
    v_exp_f32 v27, v27
    v_exp_f32 v28, v28
    v_exp_f32 v29, v29
    v_exp_f32 v30, v30
    v_exp_f32 v31, v31
    s_setprio 3
    s_waitcnt lgkmcnt(0)
    v_mfma_f32_32x32x4_2b_bf16 v[32:63], v[112:113], v[104:105], 4.0 cbsz:1 abid:1
    ds_read_b64 v[118:119], v139 offset:7680
    ds_read_b64 v[108:109], v137 offset:7680
    ds_read_b64 v[110:111], v137 offset:7688
    v_smfmac_f32_32x32x32_bf16 v[64:79], v[120:123], v[0:7], v136
    ds_read_b64_tr_b16 v[128:129], v141 offset:6400
    ds_read_b64_tr_b16 v[130:131], v141 offset:6560
    s_nop 3
    v_smfmac_f32_32x32x32_bf16 v[64:79], v[124:127], v[8:15], v136
    ds_read_b64_tr_b16 v[132:133], v141 offset:7040
    ds_read_b64_tr_b16 v[134:135], v141 offset:7200
    s_nop 4
    v_mfma_f32_32x32x16_bf16 v[32:47], v[114:117], v[96:99], v[32:47]
    v_mfma_f32_32x32x16_bf16 v[48:63], v[114:117], v[100:103], v[48:63]
    v_smfmac_f32_32x32x32_bf16 v[80:95], v[120:123], v[16:23], v136
    v_smfmac_f32_32x32x32_bf16 v[80:95], v[124:127], v[24:31], v136
    s_nop 7
    s_setprio 0
    v_exp_f32 v32, v32
    v_exp_f32 v33, v33
    v_exp_f32 v34, v34
    v_exp_f32 v35, v35
    v_exp_f32 v36, v36
    v_exp_f32 v37, v37
    v_exp_f32 v38, v38
    v_exp_f32 v39, v39
    v_exp_f32 v40, v40
    v_exp_f32 v41, v41
    v_exp_f32 v42, v42
    v_exp_f32 v43, v43
    v_exp_f32 v44, v44
    v_exp_f32 v45, v45
    v_exp_f32 v46, v46
    v_exp_f32 v47, v47
    v_exp_f32 v48, v48
    s_setprio 2
    v_exp_f32 v49, v49
    v_exp_f32 v50, v50
    v_exp_f32 v51, v51
    v_exp_f32 v52, v52
    v_exp_f32 v53, v53
    v_exp_f32 v54, v54
    v_exp_f32 v55, v55
    v_exp_f32 v56, v56
    v_exp_f32 v57, v57
    v_exp_f32 v58, v58
    v_exp_f32 v59, v59
    v_exp_f32 v60, v60
    v_exp_f32 v61, v61
    v_exp_f32 v62, v62
    v_exp_f32 v63, v63
    s_setprio 3
    s_waitcnt lgkmcnt(0)
    v_mfma_f32_32x32x4_2b_bf16 v[0:31], v[118:119], v[104:105], 4.0 cbsz:1 abid:0
    ds_read_b64 v[114:115], v137 offset:8960
    ds_read_b64 v[116:117], v137 offset:8968
    v_smfmac_f32_32x32x32_bf16 v[64:79], v[128:131], v[32:39], v136
    ds_read_b64_tr_b16 v[120:121], v141 offset:7680
    ds_read_b64_tr_b16 v[122:123], v141 offset:7840
    s_nop 4
    v_smfmac_f32_32x32x32_bf16 v[64:79], v[132:135], v[40:47], v136
    ds_read_b64_tr_b16 v[124:125], v141 offset:8320
    ds_read_b64_tr_b16 v[126:127], v141 offset:8480
    s_nop 4
    v_mfma_f32_32x32x16_bf16 v[0:15], v[108:111], v[96:99], v[0:15]
    v_mfma_f32_32x32x16_bf16 v[16:31], v[108:111], v[100:103], v[16:31]
    v_smfmac_f32_32x32x32_bf16 v[80:95], v[128:131], v[48:55], v136
    v_smfmac_f32_32x32x32_bf16 v[80:95], v[132:135], v[56:63], v136
    s_nop 7
    s_setprio 0
    v_exp_f32 v0, v0
    v_exp_f32 v1, v1
    v_exp_f32 v2, v2
    v_exp_f32 v3, v3
    v_exp_f32 v4, v4
    v_exp_f32 v5, v5
    v_exp_f32 v6, v6
    v_exp_f32 v7, v7
    v_exp_f32 v8, v8
    v_exp_f32 v9, v9
    v_exp_f32 v10, v10
    v_exp_f32 v11, v11
    v_exp_f32 v12, v12
    v_exp_f32 v13, v13
    v_exp_f32 v14, v14
    v_exp_f32 v15, v15
    v_exp_f32 v16, v16
    s_setprio 2
    v_exp_f32 v17, v17
    v_exp_f32 v18, v18
    v_exp_f32 v19, v19
    v_exp_f32 v20, v20
    v_exp_f32 v21, v21
    v_exp_f32 v22, v22
    v_exp_f32 v23, v23
    v_exp_f32 v24, v24
    v_exp_f32 v25, v25
    v_exp_f32 v26, v26
    v_exp_f32 v27, v27
    v_exp_f32 v28, v28
    v_exp_f32 v29, v29
    v_exp_f32 v30, v30
    v_exp_f32 v31, v31
    s_setprio 3
    s_waitcnt lgkmcnt(0)
    v_mfma_f32_32x32x4_2b_bf16 v[32:63], v[118:119], v[104:105], 4.0 cbsz:1 abid:1
    ds_read_b64_tr_b16 v[128:129], v141 offset:8960
    ds_read_b64_tr_b16 v[130:131], v141 offset:9120
    ds_read_b64_tr_b16 v[132:133], v141 offset:9600
    v_smfmac_f32_32x32x32_bf16 v[64:79], v[120:123], v[0:7], v136
    ds_read_b64_tr_b16 v[134:135], v141 offset:9760
    s_nop 5
    v_smfmac_f32_32x32x32_bf16 v[64:79], v[124:127], v[8:15], v136
    s_nop 5
    v_mfma_f32_32x32x16_bf16 v[32:47], v[114:117], v[96:99], v[32:47]
    v_mfma_f32_32x32x16_bf16 v[48:63], v[114:117], v[100:103], v[48:63]
    v_smfmac_f32_32x32x32_bf16 v[80:95], v[120:123], v[16:23], v136
    v_smfmac_f32_32x32x32_bf16 v[80:95], v[124:127], v[24:31], v136
    s_nop 7
    s_setprio 0
    v_exp_f32 v32, v32
    v_exp_f32 v33, v33
    v_exp_f32 v34, v34
    v_exp_f32 v35, v35
    v_exp_f32 v36, v36
    v_exp_f32 v37, v37
    v_exp_f32 v38, v38
    v_exp_f32 v39, v39
    v_exp_f32 v40, v40
    v_exp_f32 v41, v41
    v_exp_f32 v42, v42
    v_exp_f32 v43, v43
    v_exp_f32 v44, v44
    v_exp_f32 v45, v45
    v_exp_f32 v46, v46
    v_exp_f32 v47, v47
    v_exp_f32 v48, v48
    s_setprio 2
    v_exp_f32 v49, v49
    v_exp_f32 v50, v50
    v_exp_f32 v51, v51
    v_exp_f32 v52, v52
    v_exp_f32 v53, v53
    v_exp_f32 v54, v54
    v_exp_f32 v55, v55
    v_exp_f32 v56, v56
    v_exp_f32 v57, v57
    v_exp_f32 v58, v58
    v_exp_f32 v59, v59
    v_exp_f32 v60, v60
    v_exp_f32 v61, v61
    v_exp_f32 v62, v62
    v_exp_f32 v63, v63
    s_setprio 3
    s_waitcnt lgkmcnt(0)
    v_smfmac_f32_32x32x32_bf16 v[64:79], v[128:131], v[32:39], v136
    v_smfmac_f32_32x32x32_bf16 v[64:79], v[132:135], v[40:47], v136
    v_smfmac_f32_32x32x32_bf16 v[80:95], v[128:131], v[48:55], v136
    v_smfmac_f32_32x32x32_bf16 v[80:95], v[132:135], v[56:63], v136
    s_nop 4
    s_setprio 3
    s_mul_i32 s42, s32, 2560
    s_add_u32 s42, s42, 20480
    v_add_u32 v8, s42, v162
    v_add_u32 v10, s42, v149
    v_mov_b32 v0, v72
    v_mov_b32 v1, v72
    s_nop 1
    v_permlane32_swap_b32 v0, v1
    s_nop 0
    v_rcp_f32 v4, v1
    s_nop 0
    v_pk_mul_f32 v[64:65], v[64:65], v[4:5] op_sel_hi:[1,0]
    v_pk_mul_f32 v[66:67], v[66:67], v[4:5] op_sel_hi:[1,0]
    v_pk_mul_f32 v[68:69], v[68:69], v[4:5] op_sel_hi:[1,0]
    v_pk_mul_f32 v[70:71], v[70:71], v[4:5] op_sel_hi:[1,0]
    v_pk_mul_f32 v[72:73], v[72:73], v[4:5] op_sel_hi:[1,0]
    v_pk_mul_f32 v[74:75], v[74:75], v[4:5] op_sel_hi:[1,0]
    v_cvt_pk_bf16_f32 v16, v64, v65
    v_cvt_pk_bf16_f32 v17, v66, v67
    v_cvt_pk_bf16_f32 v18, v68, v69
    v_cvt_pk_bf16_f32 v19, v70, v71
    v_cvt_pk_bf16_f32 v20, v72, v73
    v_cvt_pk_bf16_f32 v21, v74, v75
    ds_write_b64 v8, v[16:17] offset:0
    ds_write_b64 v8, v[18:19] offset:16
    s_mov_b32 exec_hi, 0
    ds_write_b64 v8, v[20:21] offset:32
    s_mov_b32 exec_hi, -1
    ds_read_b128 v[12:15], v10
    s_branch L_norm
L_run1:
    s_barrier
    s_setprio 1
    v_exp_f32 v0, v0
    v_exp_f32 v1, v1
    v_exp_f32 v2, v2
    v_exp_f32 v3, v3
    v_exp_f32 v4, v4
    v_exp_f32 v5, v5
    v_exp_f32 v6, v6
    v_exp_f32 v7, v7
    v_exp_f32 v8, v8
    v_exp_f32 v9, v9
    v_exp_f32 v10, v10
    v_exp_f32 v11, v11
    v_exp_f32 v12, v12
    v_exp_f32 v13, v13
    v_exp_f32 v14, v14
    v_exp_f32 v15, v15
    v_exp_f32 v16, v16
    v_exp_f32 v17, v17
    v_exp_f32 v18, v18
    v_exp_f32 v19, v19
    v_exp_f32 v20, v20
    v_exp_f32 v21, v21
    v_exp_f32 v22, v22
    v_exp_f32 v23, v23
    v_exp_f32 v24, v24
    v_exp_f32 v25, v25
    v_exp_f32 v26, v26
    v_exp_f32 v27, v27
    v_exp_f32 v28, v28
    v_exp_f32 v29, v29
    v_exp_f32 v30, v30
    v_exp_f32 v31, v31
    s_setprio 3
    s_waitcnt lgkmcnt(0)
    v_mfma_f32_32x32x4_2b_bf16 v[32:63], v[112:113], v[104:105], 4.0 cbsz:1 abid:1
    ds_read_b64 v[118:119], v139 offset:2560
    ds_read_b64 v[108:109], v137 offset:2560
    ds_read_b64 v[110:111], v137 offset:2568
    v_smfmac_f32_32x32x32_bf16 v[64:79], v[120:123], v[0:7], v136
    ds_read_b64_tr_b16 v[128:129], v141 offset:1280
    ds_read_b64_tr_b16 v[130:131], v141 offset:1440
    s_nop 3
    v_smfmac_f32_32x32x32_bf16 v[64:79], v[124:127], v[8:15], v136
    ds_read_b64_tr_b16 v[132:133], v141 offset:1920
    ds_read_b64_tr_b16 v[134:135], v141 offset:2080
    s_nop 4
    v_mfma_f32_32x32x16_bf16 v[32:47], v[114:117], v[96:99], v[32:47]
    v_mfma_f32_32x32x16_bf16 v[48:63], v[114:117], v[100:103], v[48:63]
    v_smfmac_f32_32x32x32_bf16 v[80:95], v[120:123], v[16:23], v136
    v_smfmac_f32_32x32x32_bf16 v[80:95], v[124:127], v[24:31], v136
    s_nop 7
    s_setprio 1
    v_exp_f32 v32, v32
    v_exp_f32 v33, v33
    v_exp_f32 v34, v34
    v_exp_f32 v35, v35
    v_exp_f32 v36, v36
    v_exp_f32 v37, v37
    v_exp_f32 v38, v38
    v_exp_f32 v39, v39
    v_exp_f32 v40, v40
    v_exp_f32 v41, v41
    v_exp_f32 v42, v42
    v_exp_f32 v43, v43
    v_exp_f32 v44, v44
    v_exp_f32 v45, v45
    v_exp_f32 v46, v46
    v_exp_f32 v47, v47
    v_exp_f32 v48, v48
    v_exp_f32 v49, v49
    v_exp_f32 v50, v50
    v_exp_f32 v51, v51
    v_exp_f32 v52, v52
    v_exp_f32 v53, v53
    v_exp_f32 v54, v54
    v_exp_f32 v55, v55
    v_exp_f32 v56, v56
    v_exp_f32 v57, v57
    v_exp_f32 v58, v58
    v_exp_f32 v59, v59
    v_exp_f32 v60, v60
    v_exp_f32 v61, v61
    v_exp_f32 v62, v62
    v_exp_f32 v63, v63
    s_setprio 3
    s_waitcnt lgkmcnt(0)
    v_mfma_f32_32x32x4_2b_bf16 v[0:31], v[118:119], v[104:105], 4.0 cbsz:1 abid:0
    ds_read_b64 v[114:115], v137 offset:3840
    ds_read_b64 v[116:117], v137 offset:3848
    v_smfmac_f32_32x32x32_bf16 v[64:79], v[128:131], v[32:39], v136
    ds_read_b64_tr_b16 v[120:121], v141 offset:2560
    ds_read_b64_tr_b16 v[122:123], v141 offset:2720
    s_nop 4
    v_smfmac_f32_32x32x32_bf16 v[64:79], v[132:135], v[40:47], v136
    ds_read_b64_tr_b16 v[124:125], v141 offset:3200
    ds_read_b64_tr_b16 v[126:127], v141 offset:3360
    s_nop 4
    v_mfma_f32_32x32x16_bf16 v[0:15], v[108:111], v[96:99], v[0:15]
    v_mfma_f32_32x32x16_bf16 v[16:31], v[108:111], v[100:103], v[16:31]
    v_smfmac_f32_32x32x32_bf16 v[80:95], v[128:131], v[48:55], v136
    v_smfmac_f32_32x32x32_bf16 v[80:95], v[132:135], v[56:63], v136
    s_nop 7
    s_waitcnt vmcnt(0)
    s_barrier
    s_setprio 1
    v_exp_f32 v0, v0
    v_exp_f32 v1, v1
    v_exp_f32 v2, v2
    v_exp_f32 v3, v3
    v_exp_f32 v4, v4
    v_exp_f32 v5, v5
    v_exp_f32 v6, v6
    v_exp_f32 v7, v7
    v_exp_f32 v8, v8
    v_exp_f32 v9, v9
    v_exp_f32 v10, v10
    v_exp_f32 v11, v11
    v_exp_f32 v12, v12
    v_exp_f32 v13, v13
    v_exp_f32 v14, v14
    v_exp_f32 v15, v15
    v_exp_f32 v16, v16
    v_exp_f32 v17, v17
    v_exp_f32 v18, v18
    v_exp_f32 v19, v19
    v_exp_f32 v20, v20
    v_exp_f32 v21, v21
    v_exp_f32 v22, v22
    v_exp_f32 v23, v23
    v_exp_f32 v24, v24
    v_exp_f32 v25, v25
    v_exp_f32 v26, v26
    v_exp_f32 v27, v27
    v_exp_f32 v28, v28
    v_exp_f32 v29, v29
    v_exp_f32 v30, v30
    v_exp_f32 v31, v31
    s_setprio 3
    s_waitcnt lgkmcnt(0)
    v_mfma_f32_32x32x4_2b_bf16 v[32:63], v[118:119], v[104:105], 4.0 cbsz:1 abid:1
    ds_read_b64 v[112:113], v139 offset:5120
    ds_read_b64 v[108:109], v137 offset:5120
    ds_read_b64 v[110:111], v137 offset:5128
    s_add_u32 m0, s36, 30720
    s_add_u32 s43, s35, 30720
    buffer_load_dwordx4 v149, s[16:19], s43 offen lds
    v_smfmac_f32_32x32x32_bf16 v[64:79], v[120:123], v[0:7], v136
    ds_read_b64_tr_b16 v[128:129], v141 offset:3840
    ds_read_b64_tr_b16 v[130:131], v141 offset:4000
    s_nop 2
    v_smfmac_f32_32x32x32_bf16 v[64:79], v[124:127], v[8:15], v136
    ds_read_b64_tr_b16 v[132:133], v141 offset:4480
    ds_read_b64_tr_b16 v[134:135], v141 offset:4640
    s_nop 2
    v_mfma_f32_32x32x16_bf16 v[32:47], v[114:117], v[96:99], v[32:47]
    v_mfma_f32_32x32x16_bf16 v[48:63], v[114:117], v[100:103], v[48:63]
    v_smfmac_f32_32x32x32_bf16 v[80:95], v[120:123], v[16:23], v136
    v_smfmac_f32_32x32x32_bf16 v[80:95], v[124:127], v[24:31], v136
    s_nop 7
    s_setprio 1
    v_exp_f32 v32, v32
    v_exp_f32 v33, v33
    v_exp_f32 v34, v34
    v_exp_f32 v35, v35
    v_exp_f32 v36, v36
    v_exp_f32 v37, v37
    v_exp_f32 v38, v38
    v_exp_f32 v39, v39
    v_exp_f32 v40, v40
    v_exp_f32 v41, v41
    v_exp_f32 v42, v42
    v_exp_f32 v43, v43
    v_exp_f32 v44, v44
    v_exp_f32 v45, v45
    v_exp_f32 v46, v46
    v_exp_f32 v47, v47
    v_exp_f32 v48, v48
    v_exp_f32 v49, v49
    v_exp_f32 v50, v50
    v_exp_f32 v51, v51
    v_exp_f32 v52, v52
    v_exp_f32 v53, v53
    v_exp_f32 v54, v54
    v_exp_f32 v55, v55
    v_exp_f32 v56, v56
    v_exp_f32 v57, v57
    v_exp_f32 v58, v58
    v_exp_f32 v59, v59
    v_exp_f32 v60, v60
    v_exp_f32 v61, v61
    v_exp_f32 v62, v62
    v_exp_f32 v63, v63
    s_setprio 3
    s_waitcnt lgkmcnt(0)
    v_mfma_f32_32x32x4_2b_bf16 v[0:31], v[112:113], v[104:105], 4.0 cbsz:1 abid:0
    ds_read_b64 v[114:115], v137 offset:6400
    ds_read_b64 v[116:117], v137 offset:6408
    buffer_load_dwordx4 v149, s[16:19], s43 offen offset:1024 lds
    v_smfmac_f32_32x32x32_bf16 v[64:79], v[128:131], v[32:39], v136
    ds_read_b64_tr_b16 v[120:121], v141 offset:5120
    ds_read_b64_tr_b16 v[122:123], v141 offset:5280
    s_nop 3
    v_smfmac_f32_32x32x32_bf16 v[64:79], v[132:135], v[40:47], v136
    ds_read_b64_tr_b16 v[124:125], v141 offset:5760
    ds_read_b64_tr_b16 v[126:127], v141 offset:5920
    s_nop 4
    v_mfma_f32_32x32x16_bf16 v[0:15], v[108:111], v[96:99], v[0:15]
    v_mfma_f32_32x32x16_bf16 v[16:31], v[108:111], v[100:103], v[16:31]
    v_smfmac_f32_32x32x32_bf16 v[80:95], v[128:131], v[48:55], v136
    v_smfmac_f32_32x32x32_bf16 v[80:95], v[132:135], v[56:63], v136
    s_nop 7
    s_setprio 1
    v_exp_f32 v0, v0
    v_exp_f32 v1, v1
    v_exp_f32 v2, v2
    v_exp_f32 v3, v3
    v_exp_f32 v4, v4
    v_exp_f32 v5, v5
    v_exp_f32 v6, v6
    v_exp_f32 v7, v7
    v_exp_f32 v8, v8
    v_exp_f32 v9, v9
    v_exp_f32 v10, v10
    v_exp_f32 v11, v11
    v_exp_f32 v12, v12
    v_exp_f32 v13, v13
    v_exp_f32 v14, v14
    v_exp_f32 v15, v15
    v_exp_f32 v16, v16
    v_exp_f32 v17, v17
    v_exp_f32 v18, v18
    v_exp_f32 v19, v19
    v_exp_f32 v20, v20
    v_exp_f32 v21, v21
    v_exp_f32 v22, v22
    v_exp_f32 v23, v23
    v_exp_f32 v24, v24
    v_exp_f32 v25, v25
    v_exp_f32 v26, v26
    v_exp_f32 v27, v27
    v_exp_f32 v28, v28
    v_exp_f32 v29, v29
    v_exp_f32 v30, v30
    v_exp_f32 v31, v31
    s_setprio 3
    s_waitcnt lgkmcnt(0)
    v_mfma_f32_32x32x4_2b_bf16 v[32:63], v[112:113], v[104:105], 4.0 cbsz:1 abid:1
    ds_read_b64 v[118:119], v139 offset:7680
    ds_read_b64 v[108:109], v137 offset:7680
    ds_read_b64 v[110:111], v137 offset:7688
    buffer_load_dwordx4 v149, s[16:19], s43 offen offset:2048 lds
    v_smfmac_f32_32x32x32_bf16 v[64:79], v[120:123], v[0:7], v136
    ds_read_b64_tr_b16 v[128:129], v141 offset:6400
    ds_read_b64_tr_b16 v[130:131], v141 offset:6560
    s_nop 3
    v_smfmac_f32_32x32x32_bf16 v[64:79], v[124:127], v[8:15], v136
    ds_read_b64_tr_b16 v[132:133], v141 offset:7040
    ds_read_b64_tr_b16 v[134:135], v141 offset:7200
    s_nop 3
    v_mfma_f32_32x32x16_bf16 v[32:47], v[114:117], v[96:99], v[32:47]
    v_mfma_f32_32x32x16_bf16 v[48:63], v[114:117], v[100:103], v[48:63]
    v_smfmac_f32_32x32x32_bf16 v[80:95], v[120:123], v[16:23], v136
    v_smfmac_f32_32x32x32_bf16 v[80:95], v[124:127], v[24:31], v136
    s_nop 7
    s_setprio 1
    v_exp_f32 v32, v32
    v_exp_f32 v33, v33
    v_exp_f32 v34, v34
    v_exp_f32 v35, v35
    v_exp_f32 v36, v36
    v_exp_f32 v37, v37
    v_exp_f32 v38, v38
    v_exp_f32 v39, v39
    v_exp_f32 v40, v40
    v_exp_f32 v41, v41
    v_exp_f32 v42, v42
    v_exp_f32 v43, v43
    v_exp_f32 v44, v44
    v_exp_f32 v45, v45
    v_exp_f32 v46, v46
    v_exp_f32 v47, v47
    v_exp_f32 v48, v48
    v_exp_f32 v49, v49
    v_exp_f32 v50, v50
    v_exp_f32 v51, v51
    v_exp_f32 v52, v52
    v_exp_f32 v53, v53
    v_exp_f32 v54, v54
    v_exp_f32 v55, v55
    v_exp_f32 v56, v56
    v_exp_f32 v57, v57
    v_exp_f32 v58, v58
    v_exp_f32 v59, v59
    v_exp_f32 v60, v60
    v_exp_f32 v61, v61
    v_exp_f32 v62, v62
    v_exp_f32 v63, v63
    s_setprio 3
    s_waitcnt lgkmcnt(0)
    v_mfma_f32_32x32x4_2b_bf16 v[0:31], v[118:119], v[104:105], 4.0 cbsz:1 abid:0
    ds_read_b64 v[114:115], v137 offset:8960
    ds_read_b64 v[116:117], v137 offset:8968
    buffer_load_dwordx4 v149, s[16:19], s43 offen offset:3072 lds
    v_smfmac_f32_32x32x32_bf16 v[64:79], v[128:131], v[32:39], v136
    ds_read_b64_tr_b16 v[120:121], v141 offset:7680
    ds_read_b64_tr_b16 v[122:123], v141 offset:7840
    s_nop 3
    v_smfmac_f32_32x32x32_bf16 v[64:79], v[132:135], v[40:47], v136
    ds_read_b64_tr_b16 v[124:125], v141 offset:8320
    ds_read_b64_tr_b16 v[126:127], v141 offset:8480
    s_nop 4
    v_mfma_f32_32x32x16_bf16 v[0:15], v[108:111], v[96:99], v[0:15]
    v_mfma_f32_32x32x16_bf16 v[16:31], v[108:111], v[100:103], v[16:31]
    v_smfmac_f32_32x32x32_bf16 v[80:95], v[128:131], v[48:55], v136
    v_smfmac_f32_32x32x32_bf16 v[80:95], v[132:135], v[56:63], v136
    s_nop 7
    s_setprio 1
    v_exp_f32 v0, v0
    v_exp_f32 v1, v1
    v_exp_f32 v2, v2
    v_exp_f32 v3, v3
    v_exp_f32 v4, v4
    v_exp_f32 v5, v5
    v_exp_f32 v6, v6
    v_exp_f32 v7, v7
    v_exp_f32 v8, v8
    v_exp_f32 v9, v9
    v_exp_f32 v10, v10
    v_exp_f32 v11, v11
    v_exp_f32 v12, v12
    v_exp_f32 v13, v13
    v_exp_f32 v14, v14
    v_exp_f32 v15, v15
    v_exp_f32 v16, v16
    v_exp_f32 v17, v17
    v_exp_f32 v18, v18
    v_exp_f32 v19, v19
    v_exp_f32 v20, v20
    v_exp_f32 v21, v21
    v_exp_f32 v22, v22
    v_exp_f32 v23, v23
    v_exp_f32 v24, v24
    v_exp_f32 v25, v25
    v_exp_f32 v26, v26
    v_exp_f32 v27, v27
    v_exp_f32 v28, v28
    v_exp_f32 v29, v29
    v_exp_f32 v30, v30
    v_exp_f32 v31, v31
    s_setprio 3
    s_waitcnt lgkmcnt(0)
    v_mfma_f32_32x32x4_2b_bf16 v[32:63], v[118:119], v[104:105], 4.0 cbsz:1 abid:1
    ds_read_b64 v[112:113], v139 offset:10240
    ds_read_b64 v[108:109], v137 offset:10240
    ds_read_b64 v[110:111], v137 offset:10248
    s_add_u32 m0, s36, 34816
    s_add_u32 s43, s35, 34816
    buffer_load_dwordx4 v149, s[16:19], s43 offen lds
    v_smfmac_f32_32x32x32_bf16 v[64:79], v[120:123], v[0:7], v136
    ds_read_b64_tr_b16 v[128:129], v141 offset:8960
    ds_read_b64_tr_b16 v[130:131], v141 offset:9120
    s_nop 2
    v_smfmac_f32_32x32x32_bf16 v[64:79], v[124:127], v[8:15], v136
    ds_read_b64_tr_b16 v[132:133], v141 offset:9600
    ds_read_b64_tr_b16 v[134:135], v141 offset:9760
    s_nop 2
    v_mfma_f32_32x32x16_bf16 v[32:47], v[114:117], v[96:99], v[32:47]
    v_mfma_f32_32x32x16_bf16 v[48:63], v[114:117], v[100:103], v[48:63]
    v_smfmac_f32_32x32x32_bf16 v[80:95], v[120:123], v[16:23], v136
    v_smfmac_f32_32x32x32_bf16 v[80:95], v[124:127], v[24:31], v136
    s_nop 7
    s_setprio 1
    v_exp_f32 v32, v32
    v_exp_f32 v33, v33
    v_exp_f32 v34, v34
    v_exp_f32 v35, v35
    v_exp_f32 v36, v36
    v_exp_f32 v37, v37
    v_exp_f32 v38, v38
    v_exp_f32 v39, v39
    v_exp_f32 v40, v40
    v_exp_f32 v41, v41
    v_exp_f32 v42, v42
    v_exp_f32 v43, v43
    v_exp_f32 v44, v44
    v_exp_f32 v45, v45
    v_exp_f32 v46, v46
    v_exp_f32 v47, v47
    v_exp_f32 v48, v48
    v_exp_f32 v49, v49
    v_exp_f32 v50, v50
    v_exp_f32 v51, v51
    v_exp_f32 v52, v52
    v_exp_f32 v53, v53
    v_exp_f32 v54, v54
    v_exp_f32 v55, v55
    v_exp_f32 v56, v56
    v_exp_f32 v57, v57
    v_exp_f32 v58, v58
    v_exp_f32 v59, v59
    v_exp_f32 v60, v60
    v_exp_f32 v61, v61
    v_exp_f32 v62, v62
    v_exp_f32 v63, v63
    s_setprio 3
    s_waitcnt lgkmcnt(0)
    v_mfma_f32_32x32x4_2b_bf16 v[0:31], v[112:113], v[104:105], 4.0 cbsz:1 abid:0
    ds_read_b64 v[114:115], v137 offset:11520
    ds_read_b64 v[116:117], v137 offset:11528
    v_smfmac_f32_32x32x32_bf16 v[64:79], v[128:131], v[32:39], v136
    ds_read_b64_tr_b16 v[120:121], v142 offset:0
    ds_read_b64_tr_b16 v[122:123], v142 offset:160
    s_nop 4
    v_smfmac_f32_32x32x32_bf16 v[64:79], v[132:135], v[40:47], v136
    ds_read_b64_tr_b16 v[124:125], v142 offset:640
    ds_read_b64_tr_b16 v[126:127], v142 offset:800
    s_nop 4
    v_mfma_f32_32x32x16_bf16 v[0:15], v[108:111], v[96:99], v[0:15]
    v_mfma_f32_32x32x16_bf16 v[16:31], v[108:111], v[100:103], v[16:31]
    v_smfmac_f32_32x32x32_bf16 v[80:95], v[128:131], v[48:55], v136
    v_smfmac_f32_32x32x32_bf16 v[80:95], v[132:135], v[56:63], v136
    s_nop 7
    s_setprio 1
    v_exp_f32 v0, v0
    v_exp_f32 v1, v1
    v_exp_f32 v2, v2
    v_exp_f32 v3, v3
    v_exp_f32 v4, v4
    v_exp_f32 v5, v5
    v_exp_f32 v6, v6
    v_exp_f32 v7, v7
    v_exp_f32 v8, v8
    v_exp_f32 v9, v9
    v_exp_f32 v10, v10
    v_exp_f32 v11, v11
    v_exp_f32 v12, v12
    v_exp_f32 v13, v13
    v_exp_f32 v14, v14
    v_exp_f32 v15, v15
    v_exp_f32 v16, v16
    v_exp_f32 v17, v17
    v_exp_f32 v18, v18
    v_exp_f32 v19, v19
    v_exp_f32 v20, v20
    v_exp_f32 v21, v21
    v_exp_f32 v22, v22
    v_exp_f32 v23, v23
    v_exp_f32 v24, v24
    v_exp_f32 v25, v25
    v_exp_f32 v26, v26
    v_exp_f32 v27, v27
    v_exp_f32 v28, v28
    v_exp_f32 v29, v29
    v_exp_f32 v30, v30
    v_exp_f32 v31, v31
    s_setprio 3
    s_waitcnt lgkmcnt(0)
    v_mfma_f32_32x32x4_2b_bf16 v[32:63], v[112:113], v[104:105], 4.0 cbsz:1 abid:1
    ds_read_b64 v[118:119], v139 offset:12800
    ds_read_b64 v[108:109], v137 offset:12800
    ds_read_b64 v[110:111], v137 offset:12808
    v_smfmac_f32_32x32x32_bf16 v[64:79], v[120:123], v[0:7], v136
    ds_read_b64_tr_b16 v[128:129], v142 offset:1280
    ds_read_b64_tr_b16 v[130:131], v142 offset:1440
    s_nop 3
    v_smfmac_f32_32x32x32_bf16 v[64:79], v[124:127], v[8:15], v136
    ds_read_b64_tr_b16 v[132:133], v142 offset:1920
    ds_read_b64_tr_b16 v[134:135], v142 offset:2080
    s_nop 4
    v_mfma_f32_32x32x16_bf16 v[32:47], v[114:117], v[96:99], v[32:47]
    v_mfma_f32_32x32x16_bf16 v[48:63], v[114:117], v[100:103], v[48:63]
    v_smfmac_f32_32x32x32_bf16 v[80:95], v[120:123], v[16:23], v136
    v_smfmac_f32_32x32x32_bf16 v[80:95], v[124:127], v[24:31], v136
    s_nop 7
    s_setprio 1
    v_exp_f32 v32, v32
    v_exp_f32 v33, v33
    v_exp_f32 v34, v34
    v_exp_f32 v35, v35
    v_exp_f32 v36, v36
    v_exp_f32 v37, v37
    v_exp_f32 v38, v38
    v_exp_f32 v39, v39
    v_exp_f32 v40, v40
    v_exp_f32 v41, v41
    v_exp_f32 v42, v42
    v_exp_f32 v43, v43
    v_exp_f32 v44, v44
    v_exp_f32 v45, v45
    v_exp_f32 v46, v46
    v_exp_f32 v47, v47
    v_exp_f32 v48, v48
    v_exp_f32 v49, v49
    v_exp_f32 v50, v50
    v_exp_f32 v51, v51
    v_exp_f32 v52, v52
    v_exp_f32 v53, v53
    v_exp_f32 v54, v54
    v_exp_f32 v55, v55
    v_exp_f32 v56, v56
    v_exp_f32 v57, v57
    v_exp_f32 v58, v58
    v_exp_f32 v59, v59
    v_exp_f32 v60, v60
    v_exp_f32 v61, v61
    v_exp_f32 v62, v62
    v_exp_f32 v63, v63
    s_setprio 3
    s_waitcnt lgkmcnt(0)
    v_mfma_f32_32x32x4_2b_bf16 v[0:31], v[118:119], v[104:105], 4.0 cbsz:1 abid:0
    ds_read_b64 v[114:115], v137 offset:14080
    ds_read_b64 v[116:117], v137 offset:14088
    v_smfmac_f32_32x32x32_bf16 v[64:79], v[128:131], v[32:39], v136
    ds_read_b64_tr_b16 v[120:121], v142 offset:2560
    ds_read_b64_tr_b16 v[122:123], v142 offset:2720
    s_nop 4
    v_smfmac_f32_32x32x32_bf16 v[64:79], v[132:135], v[40:47], v136
    ds_read_b64_tr_b16 v[124:125], v142 offset:3200
    ds_read_b64_tr_b16 v[126:127], v142 offset:3360
    s_nop 4
    v_mfma_f32_32x32x16_bf16 v[0:15], v[108:111], v[96:99], v[0:15]
    v_mfma_f32_32x32x16_bf16 v[16:31], v[108:111], v[100:103], v[16:31]
    v_smfmac_f32_32x32x32_bf16 v[80:95], v[128:131], v[48:55], v136
    v_smfmac_f32_32x32x32_bf16 v[80:95], v[132:135], v[56:63], v136
    s_nop 7
    s_waitcnt vmcnt(0)
    s_barrier
    s_setprio 1
    v_exp_f32 v0, v0
    v_exp_f32 v1, v1
    v_exp_f32 v2, v2
    v_exp_f32 v3, v3
    v_exp_f32 v4, v4
    v_exp_f32 v5, v5
    v_exp_f32 v6, v6
    v_exp_f32 v7, v7
    v_exp_f32 v8, v8
    v_exp_f32 v9, v9
    v_exp_f32 v10, v10
    v_exp_f32 v11, v11
    v_exp_f32 v12, v12
    v_exp_f32 v13, v13
    v_exp_f32 v14, v14
    v_exp_f32 v15, v15
    v_exp_f32 v16, v16
    v_exp_f32 v17, v17
    v_exp_f32 v18, v18
    v_exp_f32 v19, v19
    v_exp_f32 v20, v20
    v_exp_f32 v21, v21
    v_exp_f32 v22, v22
    v_exp_f32 v23, v23
    v_exp_f32 v24, v24
    v_exp_f32 v25, v25
    v_exp_f32 v26, v26
    v_exp_f32 v27, v27
    v_exp_f32 v28, v28
    v_exp_f32 v29, v29
    v_exp_f32 v30, v30
    v_exp_f32 v31, v31
    s_setprio 3
    s_waitcnt lgkmcnt(0)
    v_mfma_f32_32x32x4_2b_bf16 v[32:63], v[118:119], v[104:105], 4.0 cbsz:1 abid:1
    ds_read_b64 v[112:113], v139 offset:15360
    ds_read_b64 v[108:109], v137 offset:15360
    ds_read_b64 v[110:111], v137 offset:15368
    s_add_u32 m0, s36, 51200
    s_add_u32 s43, s35, 51200
    buffer_load_dwordx4 v149, s[16:19], s43 offen lds
    v_smfmac_f32_32x32x32_bf16 v[64:79], v[120:123], v[0:7], v136
    ds_read_b64_tr_b16 v[128:129], v142 offset:3840
    ds_read_b64_tr_b16 v[130:131], v142 offset:4000
    s_nop 2
    v_smfmac_f32_32x32x32_bf16 v[64:79], v[124:127], v[8:15], v136
    ds_read_b64_tr_b16 v[132:133], v142 offset:4480
    ds_read_b64_tr_b16 v[134:135], v142 offset:4640
    s_nop 2
    v_mfma_f32_32x32x16_bf16 v[32:47], v[114:117], v[96:99], v[32:47]
    v_mfma_f32_32x32x16_bf16 v[48:63], v[114:117], v[100:103], v[48:63]
    v_smfmac_f32_32x32x32_bf16 v[80:95], v[120:123], v[16:23], v136
    v_smfmac_f32_32x32x32_bf16 v[80:95], v[124:127], v[24:31], v136
    s_nop 7
    s_setprio 1
    v_exp_f32 v32, v32
    v_exp_f32 v33, v33
    v_exp_f32 v34, v34
    v_exp_f32 v35, v35
    v_exp_f32 v36, v36
    v_exp_f32 v37, v37
    v_exp_f32 v38, v38
    v_exp_f32 v39, v39
    v_exp_f32 v40, v40
    v_exp_f32 v41, v41
    v_exp_f32 v42, v42
    v_exp_f32 v43, v43
    v_exp_f32 v44, v44
    v_exp_f32 v45, v45
    v_exp_f32 v46, v46
    v_exp_f32 v47, v47
    v_exp_f32 v48, v48
    v_exp_f32 v49, v49
    v_exp_f32 v50, v50
    v_exp_f32 v51, v51
    v_exp_f32 v52, v52
    v_exp_f32 v53, v53
    v_exp_f32 v54, v54
    v_exp_f32 v55, v55
    v_exp_f32 v56, v56
    v_exp_f32 v57, v57
    v_exp_f32 v58, v58
    v_exp_f32 v59, v59
    v_exp_f32 v60, v60
    v_exp_f32 v61, v61
    v_exp_f32 v62, v62
    v_exp_f32 v63, v63
    s_setprio 3
    s_waitcnt lgkmcnt(0)
    v_mfma_f32_32x32x4_2b_bf16 v[0:31], v[112:113], v[104:105], 4.0 cbsz:1 abid:0
    ds_read_b64 v[114:115], v137 offset:16640
    ds_read_b64 v[116:117], v137 offset:16648
    buffer_load_dwordx4 v149, s[16:19], s43 offen offset:1024 lds
    v_smfmac_f32_32x32x32_bf16 v[64:79], v[128:131], v[32:39], v136
    ds_read_b64_tr_b16 v[120:121], v142 offset:5120
    ds_read_b64_tr_b16 v[122:123], v142 offset:5280
    s_nop 3
    v_smfmac_f32_32x32x32_bf16 v[64:79], v[132:135], v[40:47], v136
    ds_read_b64_tr_b16 v[124:125], v142 offset:5760
    ds_read_b64_tr_b16 v[126:127], v142 offset:5920
    s_nop 4
    v_mfma_f32_32x32x16_bf16 v[0:15], v[108:111], v[96:99], v[0:15]
    v_mfma_f32_32x32x16_bf16 v[16:31], v[108:111], v[100:103], v[16:31]
    v_smfmac_f32_32x32x32_bf16 v[80:95], v[128:131], v[48:55], v136
    v_smfmac_f32_32x32x32_bf16 v[80:95], v[132:135], v[56:63], v136
    s_nop 7
    s_setprio 1
    v_exp_f32 v0, v0
    v_exp_f32 v1, v1
    v_exp_f32 v2, v2
    v_exp_f32 v3, v3
    v_exp_f32 v4, v4
    v_exp_f32 v5, v5
    v_exp_f32 v6, v6
    v_exp_f32 v7, v7
    v_exp_f32 v8, v8
    v_exp_f32 v9, v9
    v_exp_f32 v10, v10
    v_exp_f32 v11, v11
    v_exp_f32 v12, v12
    v_exp_f32 v13, v13
    v_exp_f32 v14, v14
    v_exp_f32 v15, v15
    v_exp_f32 v16, v16
    v_exp_f32 v17, v17
    v_exp_f32 v18, v18
    v_exp_f32 v19, v19
    v_exp_f32 v20, v20
    v_exp_f32 v21, v21
    v_exp_f32 v22, v22
    v_exp_f32 v23, v23
    v_exp_f32 v24, v24
    v_exp_f32 v25, v25
    v_exp_f32 v26, v26
    v_exp_f32 v27, v27
    v_exp_f32 v28, v28
    v_exp_f32 v29, v29
    v_exp_f32 v30, v30
    v_exp_f32 v31, v31
    s_setprio 3
    s_waitcnt lgkmcnt(0)
    v_mfma_f32_32x32x4_2b_bf16 v[32:63], v[112:113], v[104:105], 4.0 cbsz:1 abid:1
    ds_read_b64 v[118:119], v139 offset:17920
    ds_read_b64 v[108:109], v137 offset:17920
    ds_read_b64 v[110:111], v137 offset:17928
    buffer_load_dwordx4 v149, s[16:19], s43 offen offset:2048 lds
    v_smfmac_f32_32x32x32_bf16 v[64:79], v[120:123], v[0:7], v136
    ds_read_b64_tr_b16 v[128:129], v142 offset:6400
    ds_read_b64_tr_b16 v[130:131], v142 offset:6560
    s_nop 3
    v_smfmac_f32_32x32x32_bf16 v[64:79], v[124:127], v[8:15], v136
    ds_read_b64_tr_b16 v[132:133], v142 offset:7040
    ds_read_b64_tr_b16 v[134:135], v142 offset:7200
    s_nop 3
    v_mfma_f32_32x32x16_bf16 v[32:47], v[114:117], v[96:99], v[32:47]
    v_mfma_f32_32x32x16_bf16 v[48:63], v[114:117], v[100:103], v[48:63]
    v_smfmac_f32_32x32x32_bf16 v[80:95], v[120:123], v[16:23], v136
    v_smfmac_f32_32x32x32_bf16 v[80:95], v[124:127], v[24:31], v136
    s_nop 7
    s_setprio 1
    v_exp_f32 v32, v32
    v_exp_f32 v33, v33
    v_exp_f32 v34, v34
    v_exp_f32 v35, v35
    v_exp_f32 v36, v36
    v_exp_f32 v37, v37
    v_exp_f32 v38, v38
    v_exp_f32 v39, v39
    v_exp_f32 v40, v40
    v_exp_f32 v41, v41
    v_exp_f32 v42, v42
    v_exp_f32 v43, v43
    v_exp_f32 v44, v44
    v_exp_f32 v45, v45
    v_exp_f32 v46, v46
    v_exp_f32 v47, v47
    v_exp_f32 v48, v48
    v_exp_f32 v49, v49
    v_exp_f32 v50, v50
    v_exp_f32 v51, v51
    v_exp_f32 v52, v52
    v_exp_f32 v53, v53
    v_exp_f32 v54, v54
    v_exp_f32 v55, v55
    v_exp_f32 v56, v56
    v_exp_f32 v57, v57
    v_exp_f32 v58, v58
    v_exp_f32 v59, v59
    v_exp_f32 v60, v60
    v_exp_f32 v61, v61
    v_exp_f32 v62, v62
    v_exp_f32 v63, v63
    s_setprio 3
    s_waitcnt lgkmcnt(0)
    v_mfma_f32_32x32x4_2b_bf16 v[0:31], v[118:119], v[104:105], 4.0 cbsz:1 abid:0
    ds_read_b64 v[114:115], v137 offset:19200
    ds_read_b64 v[116:117], v137 offset:19208
    buffer_load_dwordx4 v149, s[16:19], s43 offen offset:3072 lds
    v_smfmac_f32_32x32x32_bf16 v[64:79], v[128:131], v[32:39], v136
    ds_read_b64_tr_b16 v[120:121], v142 offset:7680
    ds_read_b64_tr_b16 v[122:123], v142 offset:7840
    s_nop 3
    v_smfmac_f32_32x32x32_bf16 v[64:79], v[132:135], v[40:47], v136
    ds_read_b64_tr_b16 v[124:125], v142 offset:8320
    ds_read_b64_tr_b16 v[126:127], v142 offset:8480
    s_nop 4
    v_mfma_f32_32x32x16_bf16 v[0:15], v[108:111], v[96:99], v[0:15]
    v_mfma_f32_32x32x16_bf16 v[16:31], v[108:111], v[100:103], v[16:31]
    v_smfmac_f32_32x32x32_bf16 v[80:95], v[128:131], v[48:55], v136
    v_smfmac_f32_32x32x32_bf16 v[80:95], v[132:135], v[56:63], v136
    s_nop 7
    s_setprio 1
    v_exp_f32 v0, v0
    v_exp_f32 v1, v1
    v_exp_f32 v2, v2
    v_exp_f32 v3, v3
    v_exp_f32 v4, v4
    v_exp_f32 v5, v5
    v_exp_f32 v6, v6
    v_exp_f32 v7, v7
    v_exp_f32 v8, v8
    v_exp_f32 v9, v9
    v_exp_f32 v10, v10
    v_exp_f32 v11, v11
    v_exp_f32 v12, v12
    v_exp_f32 v13, v13
    v_exp_f32 v14, v14
    v_exp_f32 v15, v15
    v_exp_f32 v16, v16
    v_exp_f32 v17, v17
    v_exp_f32 v18, v18
    v_exp_f32 v19, v19
    v_exp_f32 v20, v20
    v_exp_f32 v21, v21
    v_exp_f32 v22, v22
    v_exp_f32 v23, v23
    v_exp_f32 v24, v24
    v_exp_f32 v25, v25
    v_exp_f32 v26, v26
    v_exp_f32 v27, v27
    v_exp_f32 v28, v28
    v_exp_f32 v29, v29
    v_exp_f32 v30, v30
    v_exp_f32 v31, v31
    s_setprio 3
    s_waitcnt lgkmcnt(0)
    v_mfma_f32_32x32x4_2b_bf16 v[32:63], v[118:119], v[104:105], 4.0 cbsz:1 abid:1
    ds_read_b64 v[112:113], v139 offset:20480
    ds_read_b64 v[108:109], v137 offset:20480
    ds_read_b64 v[110:111], v137 offset:20488
    s_add_u32 m0, s36, 55296
    s_add_u32 s43, s35, 55296
    buffer_load_dwordx4 v149, s[16:19], s43 offen lds
    v_smfmac_f32_32x32x32_bf16 v[64:79], v[120:123], v[0:7], v136
    ds_read_b64_tr_b16 v[128:129], v142 offset:8960
    ds_read_b64_tr_b16 v[130:131], v142 offset:9120
    s_nop 2
    v_smfmac_f32_32x32x32_bf16 v[64:79], v[124:127], v[8:15], v136
    ds_read_b64_tr_b16 v[132:133], v142 offset:9600
    ds_read_b64_tr_b16 v[134:135], v142 offset:9760
    s_nop 2
    v_mfma_f32_32x32x16_bf16 v[32:47], v[114:117], v[96:99], v[32:47]
    v_mfma_f32_32x32x16_bf16 v[48:63], v[114:117], v[100:103], v[48:63]
    v_smfmac_f32_32x32x32_bf16 v[80:95], v[120:123], v[16:23], v136
    v_smfmac_f32_32x32x32_bf16 v[80:95], v[124:127], v[24:31], v136
    s_nop 7
    s_setprio 1
    v_exp_f32 v32, v32
    v_exp_f32 v33, v33
    v_exp_f32 v34, v34
    v_exp_f32 v35, v35
    v_exp_f32 v36, v36
    v_exp_f32 v37, v37
    v_exp_f32 v38, v38
    v_exp_f32 v39, v39
    v_exp_f32 v40, v40
    v_exp_f32 v41, v41
    v_exp_f32 v42, v42
    v_exp_f32 v43, v43
    v_exp_f32 v44, v44
    v_exp_f32 v45, v45
    v_exp_f32 v46, v46
    v_exp_f32 v47, v47
    v_exp_f32 v48, v48
    v_exp_f32 v49, v49
    v_exp_f32 v50, v50
    v_exp_f32 v51, v51
    v_exp_f32 v52, v52
    v_exp_f32 v53, v53
    v_exp_f32 v54, v54
    v_exp_f32 v55, v55
    v_exp_f32 v56, v56
    v_exp_f32 v57, v57
    v_exp_f32 v58, v58
    v_exp_f32 v59, v59
    v_exp_f32 v60, v60
    v_exp_f32 v61, v61
    v_exp_f32 v62, v62
    v_exp_f32 v63, v63
    s_setprio 3
    s_waitcnt lgkmcnt(0)
    v_mfma_f32_32x32x4_2b_bf16 v[0:31], v[112:113], v[104:105], 4.0 cbsz:1 abid:0
    ds_read_b64 v[114:115], v137 offset:21760
    ds_read_b64 v[116:117], v137 offset:21768
    v_smfmac_f32_32x32x32_bf16 v[64:79], v[128:131], v[32:39], v136
    ds_read_b64_tr_b16 v[120:121], v143 offset:0
    ds_read_b64_tr_b16 v[122:123], v143 offset:160
    s_nop 4
    v_smfmac_f32_32x32x32_bf16 v[64:79], v[132:135], v[40:47], v136
    ds_read_b64_tr_b16 v[124:125], v143 offset:640
    ds_read_b64_tr_b16 v[126:127], v143 offset:800
    s_nop 4
    v_mfma_f32_32x32x16_bf16 v[0:15], v[108:111], v[96:99], v[0:15]
    v_mfma_f32_32x32x16_bf16 v[16:31], v[108:111], v[100:103], v[16:31]
    v_smfmac_f32_32x32x32_bf16 v[80:95], v[128:131], v[48:55], v136
    v_smfmac_f32_32x32x32_bf16 v[80:95], v[132:135], v[56:63], v136
    s_nop 7
    s_setprio 1
    v_exp_f32 v0, v0
    v_exp_f32 v1, v1
    v_exp_f32 v2, v2
    v_exp_f32 v3, v3
    v_exp_f32 v4, v4
    v_exp_f32 v5, v5
    v_exp_f32 v6, v6
    v_exp_f32 v7, v7
    v_exp_f32 v8, v8
    v_exp_f32 v9, v9
    v_exp_f32 v10, v10
    v_exp_f32 v11, v11
    v_exp_f32 v12, v12
    v_exp_f32 v13, v13
    v_exp_f32 v14, v14
    v_exp_f32 v15, v15
    v_exp_f32 v16, v16
    v_exp_f32 v17, v17
    v_exp_f32 v18, v18
    v_exp_f32 v19, v19
    v_exp_f32 v20, v20
    v_exp_f32 v21, v21
    v_exp_f32 v22, v22
    v_exp_f32 v23, v23
    v_exp_f32 v24, v24
    v_exp_f32 v25, v25
    v_exp_f32 v26, v26
    v_exp_f32 v27, v27
    v_exp_f32 v28, v28
    v_exp_f32 v29, v29
    v_exp_f32 v30, v30
    v_exp_f32 v31, v31
    s_setprio 3
    s_waitcnt lgkmcnt(0)
    v_mfma_f32_32x32x4_2b_bf16 v[32:63], v[112:113], v[104:105], 4.0 cbsz:1 abid:1
    ds_read_b64 v[118:119], v139 offset:23040
    ds_read_b64 v[108:109], v137 offset:23040
    ds_read_b64 v[110:111], v137 offset:23048
    v_smfmac_f32_32x32x32_bf16 v[64:79], v[120:123], v[0:7], v136
    ds_read_b64_tr_b16 v[128:129], v143 offset:1280
    ds_read_b64_tr_b16 v[130:131], v143 offset:1440
    s_nop 3
    v_smfmac_f32_32x32x32_bf16 v[64:79], v[124:127], v[8:15], v136
    ds_read_b64_tr_b16 v[132:133], v143 offset:1920
    ds_read_b64_tr_b16 v[134:135], v143 offset:2080
    s_nop 4
    v_mfma_f32_32x32x16_bf16 v[32:47], v[114:117], v[96:99], v[32:47]
    v_mfma_f32_32x32x16_bf16 v[48:63], v[114:117], v[100:103], v[48:63]
    v_smfmac_f32_32x32x32_bf16 v[80:95], v[120:123], v[16:23], v136
    v_smfmac_f32_32x32x32_bf16 v[80:95], v[124:127], v[24:31], v136
    s_nop 7
    s_setprio 1
    v_exp_f32 v32, v32
    v_exp_f32 v33, v33
    v_exp_f32 v34, v34
    v_exp_f32 v35, v35
    v_exp_f32 v36, v36
    v_exp_f32 v37, v37
    v_exp_f32 v38, v38
    v_exp_f32 v39, v39
    v_exp_f32 v40, v40
    v_exp_f32 v41, v41
    v_exp_f32 v42, v42
    v_exp_f32 v43, v43
    v_exp_f32 v44, v44
    v_exp_f32 v45, v45
    v_exp_f32 v46, v46
    v_exp_f32 v47, v47
    v_exp_f32 v48, v48
    v_exp_f32 v49, v49
    v_exp_f32 v50, v50
    v_exp_f32 v51, v51
    v_exp_f32 v52, v52
    v_exp_f32 v53, v53
    v_exp_f32 v54, v54
    v_exp_f32 v55, v55
    v_exp_f32 v56, v56
    v_exp_f32 v57, v57
    v_exp_f32 v58, v58
    v_exp_f32 v59, v59
    v_exp_f32 v60, v60
    v_exp_f32 v61, v61
    v_exp_f32 v62, v62
    v_exp_f32 v63, v63
    s_setprio 3
    s_waitcnt lgkmcnt(0)
    v_mfma_f32_32x32x4_2b_bf16 v[0:31], v[118:119], v[104:105], 4.0 cbsz:1 abid:0
    ds_read_b64 v[114:115], v137 offset:24320
    ds_read_b64 v[116:117], v137 offset:24328
    v_smfmac_f32_32x32x32_bf16 v[64:79], v[128:131], v[32:39], v136
    ds_read_b64_tr_b16 v[120:121], v143 offset:2560
    ds_read_b64_tr_b16 v[122:123], v143 offset:2720
    s_nop 4
    v_smfmac_f32_32x32x32_bf16 v[64:79], v[132:135], v[40:47], v136
    ds_read_b64_tr_b16 v[124:125], v143 offset:3200
    ds_read_b64_tr_b16 v[126:127], v143 offset:3360
    s_nop 4
    v_mfma_f32_32x32x16_bf16 v[0:15], v[108:111], v[96:99], v[0:15]
    v_mfma_f32_32x32x16_bf16 v[16:31], v[108:111], v[100:103], v[16:31]
    v_smfmac_f32_32x32x32_bf16 v[80:95], v[128:131], v[48:55], v136
    v_smfmac_f32_32x32x32_bf16 v[80:95], v[132:135], v[56:63], v136
    s_nop 7
    s_setprio 1
    v_exp_f32 v0, v0
    v_exp_f32 v1, v1
    v_exp_f32 v2, v2
    v_exp_f32 v3, v3
    v_exp_f32 v4, v4
    v_exp_f32 v5, v5
    v_exp_f32 v6, v6
    v_exp_f32 v7, v7
    v_exp_f32 v8, v8
    v_exp_f32 v9, v9
    v_exp_f32 v10, v10
    v_exp_f32 v11, v11
    v_exp_f32 v12, v12
    v_exp_f32 v13, v13
    v_exp_f32 v14, v14
    v_exp_f32 v15, v15
    v_exp_f32 v16, v16
    v_exp_f32 v17, v17
    v_exp_f32 v18, v18
    v_exp_f32 v19, v19
    v_exp_f32 v20, v20
    v_exp_f32 v21, v21
    v_exp_f32 v22, v22
    v_exp_f32 v23, v23
    v_exp_f32 v24, v24
    v_exp_f32 v25, v25
    v_exp_f32 v26, v26
    v_exp_f32 v27, v27
    v_exp_f32 v28, v28
    v_exp_f32 v29, v29
    v_exp_f32 v30, v30
    v_exp_f32 v31, v31
    s_setprio 3
    s_waitcnt lgkmcnt(0)
    v_mfma_f32_32x32x4_2b_bf16 v[32:63], v[118:119], v[104:105], 4.0 cbsz:1 abid:1
    ds_read_b64 v[112:113], v139 offset:25600
    ds_read_b64 v[108:109], v137 offset:25600
    ds_read_b64 v[110:111], v137 offset:25608
    v_smfmac_f32_32x32x32_bf16 v[64:79], v[120:123], v[0:7], v136
    ds_read_b64_tr_b16 v[128:129], v143 offset:3840
    ds_read_b64_tr_b16 v[130:131], v143 offset:4000
    s_nop 3
    v_smfmac_f32_32x32x32_bf16 v[64:79], v[124:127], v[8:15], v136
    ds_read_b64_tr_b16 v[132:133], v143 offset:4480
    ds_read_b64_tr_b16 v[134:135], v143 offset:4640
    s_nop 4
    v_mfma_f32_32x32x16_bf16 v[32:47], v[114:117], v[96:99], v[32:47]
    v_mfma_f32_32x32x16_bf16 v[48:63], v[114:117], v[100:103], v[48:63]
    v_smfmac_f32_32x32x32_bf16 v[80:95], v[120:123], v[16:23], v136
    v_smfmac_f32_32x32x32_bf16 v[80:95], v[124:127], v[24:31], v136
    s_nop 7
    s_setprio 1
    v_exp_f32 v32, v32
    v_exp_f32 v33, v33
    v_exp_f32 v34, v34
    v_exp_f32 v35, v35
    v_exp_f32 v36, v36
    v_exp_f32 v37, v37
    v_exp_f32 v38, v38
    v_exp_f32 v39, v39
    v_exp_f32 v40, v40
    v_exp_f32 v41, v41
    v_exp_f32 v42, v42
    v_exp_f32 v43, v43
    v_exp_f32 v44, v44
    v_exp_f32 v45, v45
    v_exp_f32 v46, v46
    v_exp_f32 v47, v47
    v_exp_f32 v48, v48
    v_exp_f32 v49, v49
    v_exp_f32 v50, v50
    v_exp_f32 v51, v51
    v_exp_f32 v52, v52
    v_exp_f32 v53, v53
    v_exp_f32 v54, v54
    v_exp_f32 v55, v55
    v_exp_f32 v56, v56
    v_exp_f32 v57, v57
    v_exp_f32 v58, v58
    v_exp_f32 v59, v59
    v_exp_f32 v60, v60
    v_exp_f32 v61, v61
    v_exp_f32 v62, v62
    v_exp_f32 v63, v63
    s_setprio 3
    s_waitcnt lgkmcnt(0)
    v_mfma_f32_32x32x4_2b_bf16 v[0:31], v[112:113], v[104:105], 4.0 cbsz:1 abid:0
    ds_read_b64 v[114:115], v137 offset:26880
    ds_read_b64 v[116:117], v137 offset:26888
    v_smfmac_f32_32x32x32_bf16 v[64:79], v[128:131], v[32:39], v136
    ds_read_b64_tr_b16 v[120:121], v143 offset:5120
    ds_read_b64_tr_b16 v[122:123], v143 offset:5280
    s_nop 4
    v_smfmac_f32_32x32x32_bf16 v[64:79], v[132:135], v[40:47], v136
    ds_read_b64_tr_b16 v[124:125], v143 offset:5760
    ds_read_b64_tr_b16 v[126:127], v143 offset:5920
    s_nop 4
    v_mfma_f32_32x32x16_bf16 v[0:15], v[108:111], v[96:99], v[0:15]
    v_mfma_f32_32x32x16_bf16 v[16:31], v[108:111], v[100:103], v[16:31]
    v_smfmac_f32_32x32x32_bf16 v[80:95], v[128:131], v[48:55], v136
    v_smfmac_f32_32x32x32_bf16 v[80:95], v[132:135], v[56:63], v136
    s_nop 7
    s_setprio 1
    v_exp_f32 v0, v0
    v_exp_f32 v1, v1
    v_exp_f32 v2, v2
    v_exp_f32 v3, v3
    v_exp_f32 v4, v4
    v_exp_f32 v5, v5
    v_exp_f32 v6, v6
    v_exp_f32 v7, v7
    v_exp_f32 v8, v8
    v_exp_f32 v9, v9
    v_exp_f32 v10, v10
    v_exp_f32 v11, v11
    v_exp_f32 v12, v12
    v_exp_f32 v13, v13
    v_exp_f32 v14, v14
    v_exp_f32 v15, v15
    v_exp_f32 v16, v16
    v_exp_f32 v17, v17
    v_exp_f32 v18, v18
    v_exp_f32 v19, v19
    v_exp_f32 v20, v20
    v_exp_f32 v21, v21
    v_exp_f32 v22, v22
    v_exp_f32 v23, v23
    v_exp_f32 v24, v24
    v_exp_f32 v25, v25
    v_exp_f32 v26, v26
    v_exp_f32 v27, v27
    v_exp_f32 v28, v28
    v_exp_f32 v29, v29
    v_exp_f32 v30, v30
    v_exp_f32 v31, v31
    s_setprio 3
    s_waitcnt lgkmcnt(0)
    v_mfma_f32_32x32x4_2b_bf16 v[32:63], v[112:113], v[104:105], 4.0 cbsz:1 abid:1
    ds_read_b64 v[118:119], v139 offset:28160
    ds_read_b64 v[108:109], v137 offset:28160
    ds_read_b64 v[110:111], v137 offset:28168
    v_smfmac_f32_32x32x32_bf16 v[64:79], v[120:123], v[0:7], v136
    ds_read_b64_tr_b16 v[128:129], v143 offset:6400
    ds_read_b64_tr_b16 v[130:131], v143 offset:6560
    s_nop 3
    v_smfmac_f32_32x32x32_bf16 v[64:79], v[124:127], v[8:15], v136
    ds_read_b64_tr_b16 v[132:133], v143 offset:7040
    ds_read_b64_tr_b16 v[134:135], v143 offset:7200
    s_nop 4
    v_mfma_f32_32x32x16_bf16 v[32:47], v[114:117], v[96:99], v[32:47]
    v_mfma_f32_32x32x16_bf16 v[48:63], v[114:117], v[100:103], v[48:63]
    v_smfmac_f32_32x32x32_bf16 v[80:95], v[120:123], v[16:23], v136
    v_smfmac_f32_32x32x32_bf16 v[80:95], v[124:127], v[24:31], v136
    s_nop 7
    s_setprio 1
    v_exp_f32 v32, v32
    v_exp_f32 v33, v33
    v_exp_f32 v34, v34
    v_exp_f32 v35, v35
    v_exp_f32 v36, v36
    v_exp_f32 v37, v37
    v_exp_f32 v38, v38
    v_exp_f32 v39, v39
    v_exp_f32 v40, v40
    v_exp_f32 v41, v41
    v_exp_f32 v42, v42
    v_exp_f32 v43, v43
    v_exp_f32 v44, v44
    v_exp_f32 v45, v45
    v_exp_f32 v46, v46
    v_exp_f32 v47, v47
    v_exp_f32 v48, v48
    v_exp_f32 v49, v49
    v_exp_f32 v50, v50
    v_exp_f32 v51, v51
    v_exp_f32 v52, v52
    v_exp_f32 v53, v53
    v_exp_f32 v54, v54
    v_exp_f32 v55, v55
    v_exp_f32 v56, v56
    v_exp_f32 v57, v57
    v_exp_f32 v58, v58
    v_exp_f32 v59, v59
    v_exp_f32 v60, v60
    v_exp_f32 v61, v61
    v_exp_f32 v62, v62
    v_exp_f32 v63, v63
    s_setprio 3
    s_waitcnt lgkmcnt(0)
    v_mfma_f32_32x32x4_2b_bf16 v[0:31], v[118:119], v[104:105], 4.0 cbsz:1 abid:0
    ds_read_b64 v[114:115], v137 offset:29440
    ds_read_b64 v[116:117], v137 offset:29448
    v_smfmac_f32_32x32x32_bf16 v[64:79], v[128:131], v[32:39], v136
    ds_read_b64_tr_b16 v[120:121], v143 offset:7680
    ds_read_b64_tr_b16 v[122:123], v143 offset:7840
    s_nop 4
    v_smfmac_f32_32x32x32_bf16 v[64:79], v[132:135], v[40:47], v136
    ds_read_b64_tr_b16 v[124:125], v143 offset:8320
    ds_read_b64_tr_b16 v[126:127], v143 offset:8480
    s_nop 4
    v_mfma_f32_32x32x16_bf16 v[0:15], v[108:111], v[96:99], v[0:15]
    v_mfma_f32_32x32x16_bf16 v[16:31], v[108:111], v[100:103], v[16:31]
    v_smfmac_f32_32x32x32_bf16 v[80:95], v[128:131], v[48:55], v136
    v_smfmac_f32_32x32x32_bf16 v[80:95], v[132:135], v[56:63], v136
    s_nop 7
    s_setprio 1
    v_exp_f32 v0, v0
    v_exp_f32 v1, v1
    v_exp_f32 v2, v2
    v_exp_f32 v3, v3
    v_exp_f32 v4, v4
    v_exp_f32 v5, v5
    v_exp_f32 v6, v6
    v_exp_f32 v7, v7
    v_exp_f32 v8, v8
    v_exp_f32 v9, v9
    v_exp_f32 v10, v10
    v_exp_f32 v11, v11
    v_exp_f32 v12, v12
    v_exp_f32 v13, v13
    v_exp_f32 v14, v14
    v_exp_f32 v15, v15
    v_exp_f32 v16, v16
    v_exp_f32 v17, v17
    v_exp_f32 v18, v18
    v_exp_f32 v19, v19
    v_exp_f32 v20, v20
    v_exp_f32 v21, v21
    v_exp_f32 v22, v22
    v_exp_f32 v23, v23
    v_exp_f32 v24, v24
    v_exp_f32 v25, v25
    v_exp_f32 v26, v26
    v_exp_f32 v27, v27
    v_exp_f32 v28, v28
    v_exp_f32 v29, v29
    v_exp_f32 v30, v30
    v_exp_f32 v31, v31
    s_setprio 3
    s_waitcnt lgkmcnt(0)
    v_mfma_f32_32x32x4_2b_bf16 v[32:63], v[118:119], v[104:105], 4.0 cbsz:1 abid:1
    ds_read_b64 v[112:113], v139 offset:30720
    ds_read_b64 v[108:109], v137 offset:30720
    ds_read_b64 v[110:111], v137 offset:30728
    v_smfmac_f32_32x32x32_bf16 v[64:79], v[120:123], v[0:7], v136
    ds_read_b64_tr_b16 v[128:129], v143 offset:8960
    ds_read_b64_tr_b16 v[130:131], v143 offset:9120
    s_nop 3
    v_smfmac_f32_32x32x32_bf16 v[64:79], v[124:127], v[8:15], v136
    ds_read_b64_tr_b16 v[132:133], v143 offset:9600
    ds_read_b64_tr_b16 v[134:135], v143 offset:9760
    s_nop 4
    v_mfma_f32_32x32x16_bf16 v[32:47], v[114:117], v[96:99], v[32:47]
    v_mfma_f32_32x32x16_bf16 v[48:63], v[114:117], v[100:103], v[48:63]
    v_smfmac_f32_32x32x32_bf16 v[80:95], v[120:123], v[16:23], v136
    v_smfmac_f32_32x32x32_bf16 v[80:95], v[124:127], v[24:31], v136
    s_nop 7
    s_setprio 1
    v_exp_f32 v32, v32
    v_exp_f32 v33, v33
    v_exp_f32 v34, v34
    v_exp_f32 v35, v35
    v_exp_f32 v36, v36
    v_exp_f32 v37, v37
    v_exp_f32 v38, v38
    v_exp_f32 v39, v39
    v_exp_f32 v40, v40
    v_exp_f32 v41, v41
    v_exp_f32 v42, v42
    v_exp_f32 v43, v43
    v_exp_f32 v44, v44
    v_exp_f32 v45, v45
    v_exp_f32 v46, v46
    v_exp_f32 v47, v47
    v_exp_f32 v48, v48
    v_exp_f32 v49, v49
    v_exp_f32 v50, v50
    v_exp_f32 v51, v51
    v_exp_f32 v52, v52
    v_exp_f32 v53, v53
    v_exp_f32 v54, v54
    v_exp_f32 v55, v55
    v_exp_f32 v56, v56
    v_exp_f32 v57, v57
    v_exp_f32 v58, v58
    v_exp_f32 v59, v59
    v_exp_f32 v60, v60
    v_exp_f32 v61, v61
    v_exp_f32 v62, v62
    v_exp_f32 v63, v63
    s_setprio 3
    s_waitcnt lgkmcnt(0)
    v_mfma_f32_32x32x4_2b_bf16 v[0:31], v[112:113], v[104:105], 4.0 cbsz:1 abid:0
    ds_read_b64 v[114:115], v137 offset:32000
    ds_read_b64 v[116:117], v137 offset:32008
    v_smfmac_f32_32x32x32_bf16 v[64:79], v[128:131], v[32:39], v136
    ds_read_b64_tr_b16 v[120:121], v144 offset:0
    ds_read_b64_tr_b16 v[122:123], v144 offset:160
    s_nop 4
    v_smfmac_f32_32x32x32_bf16 v[64:79], v[132:135], v[40:47], v136
    ds_read_b64_tr_b16 v[124:125], v144 offset:640
    ds_read_b64_tr_b16 v[126:127], v144 offset:800
    s_nop 4
    v_mfma_f32_32x32x16_bf16 v[0:15], v[108:111], v[96:99], v[0:15]
    v_mfma_f32_32x32x16_bf16 v[16:31], v[108:111], v[100:103], v[16:31]
    v_smfmac_f32_32x32x32_bf16 v[80:95], v[128:131], v[48:55], v136
    v_smfmac_f32_32x32x32_bf16 v[80:95], v[132:135], v[56:63], v136
    s_nop 7
    s_setprio 1
    v_exp_f32 v0, v0
    v_exp_f32 v1, v1
    v_exp_f32 v2, v2
    v_exp_f32 v3, v3
    v_exp_f32 v4, v4
    v_exp_f32 v5, v5
    v_exp_f32 v6, v6
    v_exp_f32 v7, v7
    v_exp_f32 v8, v8
    v_exp_f32 v9, v9
    v_exp_f32 v10, v10
    v_exp_f32 v11, v11
    v_exp_f32 v12, v12
    v_exp_f32 v13, v13
    v_exp_f32 v14, v14
    v_exp_f32 v15, v15
    v_exp_f32 v16, v16
    v_exp_f32 v17, v17
    v_exp_f32 v18, v18
    v_exp_f32 v19, v19
    v_exp_f32 v20, v20
    v_exp_f32 v21, v21
    v_exp_f32 v22, v22
    v_exp_f32 v23, v23
    v_exp_f32 v24, v24
    v_exp_f32 v25, v25
    v_exp_f32 v26, v26
    v_exp_f32 v27, v27
    v_exp_f32 v28, v28
    v_exp_f32 v29, v29
    v_exp_f32 v30, v30
    v_exp_f32 v31, v31
    s_setprio 3
    s_waitcnt lgkmcnt(0)
    v_mfma_f32_32x32x4_2b_bf16 v[32:63], v[112:113], v[104:105], 4.0 cbsz:1 abid:1
    ds_read_b64 v[118:119], v139 offset:33280
    ds_read_b64 v[108:109], v137 offset:33280
    ds_read_b64 v[110:111], v137 offset:33288
    v_smfmac_f32_32x32x32_bf16 v[64:79], v[120:123], v[0:7], v136
    ds_read_b64_tr_b16 v[128:129], v144 offset:1280
    ds_read_b64_tr_b16 v[130:131], v144 offset:1440
    s_nop 3
    v_smfmac_f32_32x32x32_bf16 v[64:79], v[124:127], v[8:15], v136
    ds_read_b64_tr_b16 v[132:133], v144 offset:1920
    ds_read_b64_tr_b16 v[134:135], v144 offset:2080
    s_nop 4
    v_mfma_f32_32x32x16_bf16 v[32:47], v[114:117], v[96:99], v[32:47]
    v_mfma_f32_32x32x16_bf16 v[48:63], v[114:117], v[100:103], v[48:63]
    v_smfmac_f32_32x32x32_bf16 v[80:95], v[120:123], v[16:23], v136
    v_smfmac_f32_32x32x32_bf16 v[80:95], v[124:127], v[24:31], v136
    s_nop 7
    s_setprio 1
    v_exp_f32 v32, v32
    v_exp_f32 v33, v33
    v_exp_f32 v34, v34
    v_exp_f32 v35, v35
    v_exp_f32 v36, v36
    v_exp_f32 v37, v37
    v_exp_f32 v38, v38
    v_exp_f32 v39, v39
    v_exp_f32 v40, v40
    v_exp_f32 v41, v41
    v_exp_f32 v42, v42
    v_exp_f32 v43, v43
    v_exp_f32 v44, v44
    v_exp_f32 v45, v45
    v_exp_f32 v46, v46
    v_exp_f32 v47, v47
    v_exp_f32 v48, v48
    v_exp_f32 v49, v49
    v_exp_f32 v50, v50
    v_exp_f32 v51, v51
    v_exp_f32 v52, v52
    v_exp_f32 v53, v53
    v_exp_f32 v54, v54
    v_exp_f32 v55, v55
    v_exp_f32 v56, v56
    v_exp_f32 v57, v57
    v_exp_f32 v58, v58
    v_exp_f32 v59, v59
    v_exp_f32 v60, v60
    v_exp_f32 v61, v61
    v_exp_f32 v62, v62
    v_exp_f32 v63, v63
    s_setprio 3
    s_waitcnt lgkmcnt(0)
    v_mfma_f32_32x32x4_2b_bf16 v[0:31], v[118:119], v[104:105], 4.0 cbsz:1 abid:0
    ds_read_b64 v[114:115], v137 offset:34560
    ds_read_b64 v[116:117], v137 offset:34568
    v_smfmac_f32_32x32x32_bf16 v[64:79], v[128:131], v[32:39], v136
    ds_read_b64_tr_b16 v[120:121], v144 offset:2560
    ds_read_b64_tr_b16 v[122:123], v144 offset:2720
    s_nop 4
    v_smfmac_f32_32x32x32_bf16 v[64:79], v[132:135], v[40:47], v136
    ds_read_b64_tr_b16 v[124:125], v144 offset:3200
    ds_read_b64_tr_b16 v[126:127], v144 offset:3360
    s_nop 4
    v_mfma_f32_32x32x16_bf16 v[0:15], v[108:111], v[96:99], v[0:15]
    v_mfma_f32_32x32x16_bf16 v[16:31], v[108:111], v[100:103], v[16:31]
    v_smfmac_f32_32x32x32_bf16 v[80:95], v[128:131], v[48:55], v136
    v_smfmac_f32_32x32x32_bf16 v[80:95], v[132:135], v[56:63], v136
    s_nop 7
    s_waitcnt vmcnt(0)
    s_barrier
    s_setprio 1
    v_exp_f32 v0, v0
    v_exp_f32 v1, v1
    v_exp_f32 v2, v2
    v_exp_f32 v3, v3
    v_exp_f32 v4, v4
    v_exp_f32 v5, v5
    v_exp_f32 v6, v6
    v_exp_f32 v7, v7
    v_exp_f32 v8, v8
    v_exp_f32 v9, v9
    v_exp_f32 v10, v10
    v_exp_f32 v11, v11
    v_exp_f32 v12, v12
    v_exp_f32 v13, v13
    v_exp_f32 v14, v14
    v_exp_f32 v15, v15
    v_exp_f32 v16, v16
    v_exp_f32 v17, v17
    v_exp_f32 v18, v18
    v_exp_f32 v19, v19
    v_exp_f32 v20, v20
    v_exp_f32 v21, v21
    v_exp_f32 v22, v22
    v_exp_f32 v23, v23
    v_exp_f32 v24, v24
    v_exp_f32 v25, v25
    v_exp_f32 v26, v26
    v_exp_f32 v27, v27
    v_exp_f32 v28, v28
    v_exp_f32 v29, v29
    v_exp_f32 v30, v30
    v_exp_f32 v31, v31
    s_setprio 3
    s_waitcnt lgkmcnt(0)
    v_mfma_f32_32x32x4_2b_bf16 v[32:63], v[118:119], v[104:105], 4.0 cbsz:1 abid:1
    ds_read_b64 v[112:113], v139 offset:35840
    ds_read_b64 v[108:109], v137 offset:35840
    ds_read_b64 v[110:111], v137 offset:35848
    s_add_u32 m0, s36, 0
    s_add_u32 s43, s35, 71680
    buffer_load_dwordx4 v149, s[16:19], s43 offen lds
    v_smfmac_f32_32x32x32_bf16 v[64:79], v[120:123], v[0:7], v136
    ds_read_b64_tr_b16 v[128:129], v144 offset:3840
    ds_read_b64_tr_b16 v[130:131], v144 offset:4000
    s_nop 2
    v_smfmac_f32_32x32x32_bf16 v[64:79], v[124:127], v[8:15], v136
    ds_read_b64_tr_b16 v[132:133], v144 offset:4480
    ds_read_b64_tr_b16 v[134:135], v144 offset:4640
    s_nop 2
    v_mfma_f32_32x32x16_bf16 v[32:47], v[114:117], v[96:99], v[32:47]
    v_mfma_f32_32x32x16_bf16 v[48:63], v[114:117], v[100:103], v[48:63]
    v_smfmac_f32_32x32x32_bf16 v[80:95], v[120:123], v[16:23], v136
    v_smfmac_f32_32x32x32_bf16 v[80:95], v[124:127], v[24:31], v136
    s_nop 7
    s_setprio 1
    v_exp_f32 v32, v32
    v_exp_f32 v33, v33
    v_exp_f32 v34, v34
    v_exp_f32 v35, v35
    v_exp_f32 v36, v36
    v_exp_f32 v37, v37
    v_exp_f32 v38, v38
    v_exp_f32 v39, v39
    v_exp_f32 v40, v40
    v_exp_f32 v41, v41
    v_exp_f32 v42, v42
    v_exp_f32 v43, v43
    v_exp_f32 v44, v44
    v_exp_f32 v45, v45
    v_exp_f32 v46, v46
    v_exp_f32 v47, v47
    v_exp_f32 v48, v48
    v_exp_f32 v49, v49
    v_exp_f32 v50, v50
    v_exp_f32 v51, v51
    v_exp_f32 v52, v52
    v_exp_f32 v53, v53
    v_exp_f32 v54, v54
    v_exp_f32 v55, v55
    v_exp_f32 v56, v56
    v_exp_f32 v57, v57
    v_exp_f32 v58, v58
    v_exp_f32 v59, v59
    v_exp_f32 v60, v60
    v_exp_f32 v61, v61
    v_exp_f32 v62, v62
    v_exp_f32 v63, v63
    s_setprio 3
    s_waitcnt lgkmcnt(0)
    v_mfma_f32_32x32x4_2b_bf16 v[0:31], v[112:113], v[104:105], 4.0 cbsz:1 abid:0
    ds_read_b64 v[114:115], v137 offset:37120
    ds_read_b64 v[116:117], v137 offset:37128
    buffer_load_dwordx4 v149, s[16:19], s43 offen offset:1024 lds
    v_smfmac_f32_32x32x32_bf16 v[64:79], v[128:131], v[32:39], v136
    ds_read_b64_tr_b16 v[120:121], v144 offset:5120
    ds_read_b64_tr_b16 v[122:123], v144 offset:5280
    s_nop 3
    v_smfmac_f32_32x32x32_bf16 v[64:79], v[132:135], v[40:47], v136
    ds_read_b64_tr_b16 v[124:125], v144 offset:5760
    ds_read_b64_tr_b16 v[126:127], v144 offset:5920
    s_nop 4
    v_mfma_f32_32x32x16_bf16 v[0:15], v[108:111], v[96:99], v[0:15]
    v_mfma_f32_32x32x16_bf16 v[16:31], v[108:111], v[100:103], v[16:31]
    v_smfmac_f32_32x32x32_bf16 v[80:95], v[128:131], v[48:55], v136
    v_smfmac_f32_32x32x32_bf16 v[80:95], v[132:135], v[56:63], v136
    s_nop 7
    s_setprio 1
    v_exp_f32 v0, v0
    v_exp_f32 v1, v1
    v_exp_f32 v2, v2
    v_exp_f32 v3, v3
    v_exp_f32 v4, v4
    v_exp_f32 v5, v5
    v_exp_f32 v6, v6
    v_exp_f32 v7, v7
    v_exp_f32 v8, v8
    v_exp_f32 v9, v9
    v_exp_f32 v10, v10
    v_exp_f32 v11, v11
    v_exp_f32 v12, v12
    v_exp_f32 v13, v13
    v_exp_f32 v14, v14
    v_exp_f32 v15, v15
    v_exp_f32 v16, v16
    v_exp_f32 v17, v17
    v_exp_f32 v18, v18
    v_exp_f32 v19, v19
    v_exp_f32 v20, v20
    v_exp_f32 v21, v21
    v_exp_f32 v22, v22
    v_exp_f32 v23, v23
    v_exp_f32 v24, v24
    v_exp_f32 v25, v25
    v_exp_f32 v26, v26
    v_exp_f32 v27, v27
    v_exp_f32 v28, v28
    v_exp_f32 v29, v29
    v_exp_f32 v30, v30
    v_exp_f32 v31, v31
    s_setprio 3
    s_waitcnt lgkmcnt(0)
    v_mfma_f32_32x32x4_2b_bf16 v[32:63], v[112:113], v[104:105], 4.0 cbsz:1 abid:1
    ds_read_b64 v[118:119], v139 offset:38400
    ds_read_b64 v[108:109], v137 offset:38400
    ds_read_b64 v[110:111], v137 offset:38408
    buffer_load_dwordx4 v149, s[16:19], s43 offen offset:2048 lds
    v_smfmac_f32_32x32x32_bf16 v[64:79], v[120:123], v[0:7], v136
    ds_read_b64_tr_b16 v[128:129], v144 offset:6400
    ds_read_b64_tr_b16 v[130:131], v144 offset:6560
    s_nop 3
    v_smfmac_f32_32x32x32_bf16 v[64:79], v[124:127], v[8:15], v136
    ds_read_b64_tr_b16 v[132:133], v144 offset:7040
    ds_read_b64_tr_b16 v[134:135], v144 offset:7200
    s_nop 3
    v_mfma_f32_32x32x16_bf16 v[32:47], v[114:117], v[96:99], v[32:47]
    v_mfma_f32_32x32x16_bf16 v[48:63], v[114:117], v[100:103], v[48:63]
    v_smfmac_f32_32x32x32_bf16 v[80:95], v[120:123], v[16:23], v136
    v_smfmac_f32_32x32x32_bf16 v[80:95], v[124:127], v[24:31], v136
    s_nop 7
    s_setprio 1
    v_exp_f32 v32, v32
    v_exp_f32 v33, v33
    v_exp_f32 v34, v34
    v_exp_f32 v35, v35
    v_exp_f32 v36, v36
    v_exp_f32 v37, v37
    v_exp_f32 v38, v38
    v_exp_f32 v39, v39
    v_exp_f32 v40, v40
    v_exp_f32 v41, v41
    v_exp_f32 v42, v42
    v_exp_f32 v43, v43
    v_exp_f32 v44, v44
    v_exp_f32 v45, v45
    v_exp_f32 v46, v46
    v_exp_f32 v47, v47
    v_exp_f32 v48, v48
    v_exp_f32 v49, v49
    v_exp_f32 v50, v50
    v_exp_f32 v51, v51
    v_exp_f32 v52, v52
    v_exp_f32 v53, v53
    v_exp_f32 v54, v54
    v_exp_f32 v55, v55
    v_exp_f32 v56, v56
    v_exp_f32 v57, v57
    v_exp_f32 v58, v58
    v_exp_f32 v59, v59
    v_exp_f32 v60, v60
    v_exp_f32 v61, v61
    v_exp_f32 v62, v62
    v_exp_f32 v63, v63
    s_setprio 3
    s_waitcnt lgkmcnt(0)
    v_mfma_f32_32x32x4_2b_bf16 v[0:31], v[118:119], v[104:105], 4.0 cbsz:1 abid:0
    ds_read_b64 v[114:115], v137 offset:39680
    ds_read_b64 v[116:117], v137 offset:39688
    buffer_load_dwordx4 v149, s[16:19], s43 offen offset:3072 lds
    v_smfmac_f32_32x32x32_bf16 v[64:79], v[128:131], v[32:39], v136
    ds_read_b64_tr_b16 v[120:121], v144 offset:7680
    ds_read_b64_tr_b16 v[122:123], v144 offset:7840
    s_nop 3
    v_smfmac_f32_32x32x32_bf16 v[64:79], v[132:135], v[40:47], v136
    ds_read_b64_tr_b16 v[124:125], v144 offset:8320
    ds_read_b64_tr_b16 v[126:127], v144 offset:8480
    s_nop 4
    v_mfma_f32_32x32x16_bf16 v[0:15], v[108:111], v[96:99], v[0:15]
    v_mfma_f32_32x32x16_bf16 v[16:31], v[108:111], v[100:103], v[16:31]
    v_smfmac_f32_32x32x32_bf16 v[80:95], v[128:131], v[48:55], v136
    v_smfmac_f32_32x32x32_bf16 v[80:95], v[132:135], v[56:63], v136
    s_nop 7
    s_setprio 1
    v_exp_f32 v0, v0
    v_exp_f32 v1, v1
    v_exp_f32 v2, v2
    v_exp_f32 v3, v3
    v_exp_f32 v4, v4
    v_exp_f32 v5, v5
    v_exp_f32 v6, v6
    v_exp_f32 v7, v7
    v_exp_f32 v8, v8
    v_exp_f32 v9, v9
    v_exp_f32 v10, v10
    v_exp_f32 v11, v11
    v_exp_f32 v12, v12
    v_exp_f32 v13, v13
    v_exp_f32 v14, v14
    v_exp_f32 v15, v15
    v_exp_f32 v16, v16
    v_exp_f32 v17, v17
    v_exp_f32 v18, v18
    v_exp_f32 v19, v19
    v_exp_f32 v20, v20
    v_exp_f32 v21, v21
    v_exp_f32 v22, v22
    v_exp_f32 v23, v23
    v_exp_f32 v24, v24
    v_exp_f32 v25, v25
    v_exp_f32 v26, v26
    v_exp_f32 v27, v27
    v_exp_f32 v28, v28
    v_exp_f32 v29, v29
    v_exp_f32 v30, v30
    v_exp_f32 v31, v31
    s_setprio 3
    s_waitcnt lgkmcnt(0)
    v_mfma_f32_32x32x4_2b_bf16 v[32:63], v[118:119], v[104:105], 4.0 cbsz:1 abid:1
    ds_read_b64 v[112:113], v139 offset:40960
    ds_read_b64 v[108:109], v137 offset:40960
    ds_read_b64 v[110:111], v137 offset:40968
    s_add_u32 m0, s36, 4096
    s_add_u32 s43, s35, 75776
    buffer_load_dwordx4 v149, s[16:19], s43 offen lds
    v_smfmac_f32_32x32x32_bf16 v[64:79], v[120:123], v[0:7], v136
    ds_read_b64_tr_b16 v[128:129], v144 offset:8960
    ds_read_b64_tr_b16 v[130:131], v144 offset:9120
    s_nop 2
    v_smfmac_f32_32x32x32_bf16 v[64:79], v[124:127], v[8:15], v136
    ds_read_b64_tr_b16 v[132:133], v144 offset:9600
    ds_read_b64_tr_b16 v[134:135], v144 offset:9760
    s_nop 2
    v_mfma_f32_32x32x16_bf16 v[32:47], v[114:117], v[96:99], v[32:47]
    v_mfma_f32_32x32x16_bf16 v[48:63], v[114:117], v[100:103], v[48:63]
    v_smfmac_f32_32x32x32_bf16 v[80:95], v[120:123], v[16:23], v136
    v_smfmac_f32_32x32x32_bf16 v[80:95], v[124:127], v[24:31], v136
    s_nop 7
    s_setprio 1
    v_exp_f32 v32, v32
    v_exp_f32 v33, v33
    v_exp_f32 v34, v34
    v_exp_f32 v35, v35
    v_exp_f32 v36, v36
    v_exp_f32 v37, v37
    v_exp_f32 v38, v38
    v_exp_f32 v39, v39
    v_exp_f32 v40, v40
    v_exp_f32 v41, v41
    v_exp_f32 v42, v42
    v_exp_f32 v43, v43
    v_exp_f32 v44, v44
    v_exp_f32 v45, v45
    v_exp_f32 v46, v46
    v_exp_f32 v47, v47
    v_exp_f32 v48, v48
    v_exp_f32 v49, v49
    v_exp_f32 v50, v50
    v_exp_f32 v51, v51
    v_exp_f32 v52, v52
    v_exp_f32 v53, v53
    v_exp_f32 v54, v54
    v_exp_f32 v55, v55
    v_exp_f32 v56, v56
    v_exp_f32 v57, v57
    v_exp_f32 v58, v58
    v_exp_f32 v59, v59
    v_exp_f32 v60, v60
    v_exp_f32 v61, v61
    v_exp_f32 v62, v62
    v_exp_f32 v63, v63
    s_setprio 3
    s_waitcnt lgkmcnt(0)
    v_mfma_f32_32x32x4_2b_bf16 v[0:31], v[112:113], v[104:105], 4.0 cbsz:1 abid:0
    ds_read_b64 v[114:115], v137 offset:42240
    ds_read_b64 v[116:117], v137 offset:42248
    v_smfmac_f32_32x32x32_bf16 v[64:79], v[128:131], v[32:39], v136
    ds_read_b64_tr_b16 v[120:121], v145 offset:0
    ds_read_b64_tr_b16 v[122:123], v145 offset:160
    s_nop 4
    v_smfmac_f32_32x32x32_bf16 v[64:79], v[132:135], v[40:47], v136
    ds_read_b64_tr_b16 v[124:125], v145 offset:640
    ds_read_b64_tr_b16 v[126:127], v145 offset:800
    s_nop 4
    v_mfma_f32_32x32x16_bf16 v[0:15], v[108:111], v[96:99], v[0:15]
    v_mfma_f32_32x32x16_bf16 v[16:31], v[108:111], v[100:103], v[16:31]
    v_smfmac_f32_32x32x32_bf16 v[80:95], v[128:131], v[48:55], v136
    v_smfmac_f32_32x32x32_bf16 v[80:95], v[132:135], v[56:63], v136
    s_nop 7
    s_setprio 1
    v_exp_f32 v0, v0
    v_exp_f32 v1, v1
    v_exp_f32 v2, v2
    v_exp_f32 v3, v3
    v_exp_f32 v4, v4
    v_exp_f32 v5, v5
    v_exp_f32 v6, v6
    v_exp_f32 v7, v7
    v_exp_f32 v8, v8
    v_exp_f32 v9, v9
    v_exp_f32 v10, v10
    v_exp_f32 v11, v11
    v_exp_f32 v12, v12
    v_exp_f32 v13, v13
    v_exp_f32 v14, v14
    v_exp_f32 v15, v15
    v_exp_f32 v16, v16
    v_exp_f32 v17, v17
    v_exp_f32 v18, v18
    v_exp_f32 v19, v19
    v_exp_f32 v20, v20
    v_exp_f32 v21, v21
    v_exp_f32 v22, v22
    v_exp_f32 v23, v23
    v_exp_f32 v24, v24
    v_exp_f32 v25, v25
    v_exp_f32 v26, v26
    v_exp_f32 v27, v27
    v_exp_f32 v28, v28
    v_exp_f32 v29, v29
    v_exp_f32 v30, v30
    v_exp_f32 v31, v31
    s_setprio 3
    s_waitcnt lgkmcnt(0)
    v_mfma_f32_32x32x4_2b_bf16 v[32:63], v[112:113], v[104:105], 4.0 cbsz:1 abid:1
    ds_read_b64 v[118:119], v139 offset:43520
    ds_read_b64 v[108:109], v137 offset:43520
    ds_read_b64 v[110:111], v137 offset:43528
    v_smfmac_f32_32x32x32_bf16 v[64:79], v[120:123], v[0:7], v136
    ds_read_b64_tr_b16 v[128:129], v145 offset:1280
    ds_read_b64_tr_b16 v[130:131], v145 offset:1440
    s_nop 3
    v_smfmac_f32_32x32x32_bf16 v[64:79], v[124:127], v[8:15], v136
    ds_read_b64_tr_b16 v[132:133], v145 offset:1920
    ds_read_b64_tr_b16 v[134:135], v145 offset:2080
    s_nop 4
    v_mfma_f32_32x32x16_bf16 v[32:47], v[114:117], v[96:99], v[32:47]
    v_mfma_f32_32x32x16_bf16 v[48:63], v[114:117], v[100:103], v[48:63]
    v_smfmac_f32_32x32x32_bf16 v[80:95], v[120:123], v[16:23], v136
    v_smfmac_f32_32x32x32_bf16 v[80:95], v[124:127], v[24:31], v136
    s_nop 7
    s_setprio 1
    v_exp_f32 v32, v32
    v_exp_f32 v33, v33
    v_exp_f32 v34, v34
    v_exp_f32 v35, v35
    v_exp_f32 v36, v36
    v_exp_f32 v37, v37
    v_exp_f32 v38, v38
    v_exp_f32 v39, v39
    v_exp_f32 v40, v40
    v_exp_f32 v41, v41
    v_exp_f32 v42, v42
    v_exp_f32 v43, v43
    v_exp_f32 v44, v44
    v_exp_f32 v45, v45
    v_exp_f32 v46, v46
    v_exp_f32 v47, v47
    v_exp_f32 v48, v48
    v_exp_f32 v49, v49
    v_exp_f32 v50, v50
    v_exp_f32 v51, v51
    v_exp_f32 v52, v52
    v_exp_f32 v53, v53
    v_exp_f32 v54, v54
    v_exp_f32 v55, v55
    v_exp_f32 v56, v56
    v_exp_f32 v57, v57
    v_exp_f32 v58, v58
    v_exp_f32 v59, v59
    v_exp_f32 v60, v60
    v_exp_f32 v61, v61
    v_exp_f32 v62, v62
    v_exp_f32 v63, v63
    s_setprio 3
    s_waitcnt lgkmcnt(0)
    v_mfma_f32_32x32x4_2b_bf16 v[0:31], v[118:119], v[104:105], 4.0 cbsz:1 abid:0
    ds_read_b64 v[114:115], v137 offset:44800
    ds_read_b64 v[116:117], v137 offset:44808
    v_smfmac_f32_32x32x32_bf16 v[64:79], v[128:131], v[32:39], v136
    ds_read_b64_tr_b16 v[120:121], v145 offset:2560
    ds_read_b64_tr_b16 v[122:123], v145 offset:2720
    s_nop 4
    v_smfmac_f32_32x32x32_bf16 v[64:79], v[132:135], v[40:47], v136
    ds_read_b64_tr_b16 v[124:125], v145 offset:3200
    ds_read_b64_tr_b16 v[126:127], v145 offset:3360
    s_nop 4
    v_mfma_f32_32x32x16_bf16 v[0:15], v[108:111], v[96:99], v[0:15]
    v_mfma_f32_32x32x16_bf16 v[16:31], v[108:111], v[100:103], v[16:31]
    v_smfmac_f32_32x32x32_bf16 v[80:95], v[128:131], v[48:55], v136
    v_smfmac_f32_32x32x32_bf16 v[80:95], v[132:135], v[56:63], v136
    s_nop 7
    s_setprio 1
    v_exp_f32 v0, v0
    v_exp_f32 v1, v1
    v_exp_f32 v2, v2
    v_exp_f32 v3, v3
    v_exp_f32 v4, v4
    v_exp_f32 v5, v5
    v_exp_f32 v6, v6
    v_exp_f32 v7, v7
    v_exp_f32 v8, v8
    v_exp_f32 v9, v9
    v_exp_f32 v10, v10
    v_exp_f32 v11, v11
    v_exp_f32 v12, v12
    v_exp_f32 v13, v13
    v_exp_f32 v14, v14
    v_exp_f32 v15, v15
    v_exp_f32 v16, v16
    v_exp_f32 v17, v17
    v_exp_f32 v18, v18
    v_exp_f32 v19, v19
    v_exp_f32 v20, v20
    v_exp_f32 v21, v21
    v_exp_f32 v22, v22
    v_exp_f32 v23, v23
    v_exp_f32 v24, v24
    v_exp_f32 v25, v25
    v_exp_f32 v26, v26
    v_exp_f32 v27, v27
    v_exp_f32 v28, v28
    v_exp_f32 v29, v29
    v_exp_f32 v30, v30
    v_exp_f32 v31, v31
    s_setprio 3
    s_waitcnt lgkmcnt(0)
    v_mfma_f32_32x32x4_2b_bf16 v[32:63], v[118:119], v[104:105], 4.0 cbsz:1 abid:1
    ds_read_b64 v[112:113], v139 offset:46080
    ds_read_b64 v[108:109], v137 offset:46080
    ds_read_b64 v[110:111], v137 offset:46088
    v_smfmac_f32_32x32x32_bf16 v[64:79], v[120:123], v[0:7], v136
    ds_read_b64_tr_b16 v[128:129], v145 offset:3840
    ds_read_b64_tr_b16 v[130:131], v145 offset:4000
    s_nop 3
    v_smfmac_f32_32x32x32_bf16 v[64:79], v[124:127], v[8:15], v136
    ds_read_b64_tr_b16 v[132:133], v145 offset:4480
    ds_read_b64_tr_b16 v[134:135], v145 offset:4640
    s_nop 4
    v_mfma_f32_32x32x16_bf16 v[32:47], v[114:117], v[96:99], v[32:47]
    v_mfma_f32_32x32x16_bf16 v[48:63], v[114:117], v[100:103], v[48:63]
    v_smfmac_f32_32x32x32_bf16 v[80:95], v[120:123], v[16:23], v136
    v_smfmac_f32_32x32x32_bf16 v[80:95], v[124:127], v[24:31], v136
    s_nop 7
    s_setprio 1
    v_exp_f32 v32, v32
    v_exp_f32 v33, v33
    v_exp_f32 v34, v34
    v_exp_f32 v35, v35
    v_exp_f32 v36, v36
    v_exp_f32 v37, v37
    v_exp_f32 v38, v38
    v_exp_f32 v39, v39
    v_exp_f32 v40, v40
    v_exp_f32 v41, v41
    v_exp_f32 v42, v42
    v_exp_f32 v43, v43
    v_exp_f32 v44, v44
    v_exp_f32 v45, v45
    v_exp_f32 v46, v46
    v_exp_f32 v47, v47
    v_exp_f32 v48, v48
    v_exp_f32 v49, v49
    v_exp_f32 v50, v50
    v_exp_f32 v51, v51
    v_exp_f32 v52, v52
    v_exp_f32 v53, v53
    v_exp_f32 v54, v54
    v_exp_f32 v55, v55
    v_exp_f32 v56, v56
    v_exp_f32 v57, v57
    v_exp_f32 v58, v58
    v_exp_f32 v59, v59
    v_exp_f32 v60, v60
    v_exp_f32 v61, v61
    v_exp_f32 v62, v62
    v_exp_f32 v63, v63
    s_setprio 3
    s_waitcnt lgkmcnt(0)
    v_mfma_f32_32x32x4_2b_bf16 v[0:31], v[112:113], v[104:105], 4.0 cbsz:1 abid:0
    ds_read_b64 v[114:115], v137 offset:47360
    ds_read_b64 v[116:117], v137 offset:47368
    v_smfmac_f32_32x32x32_bf16 v[64:79], v[128:131], v[32:39], v136
    ds_read_b64_tr_b16 v[120:121], v145 offset:5120
    ds_read_b64_tr_b16 v[122:123], v145 offset:5280
    s_nop 4
    v_smfmac_f32_32x32x32_bf16 v[64:79], v[132:135], v[40:47], v136
    ds_read_b64_tr_b16 v[124:125], v145 offset:5760
    ds_read_b64_tr_b16 v[126:127], v145 offset:5920
    s_nop 4
    v_mfma_f32_32x32x16_bf16 v[0:15], v[108:111], v[96:99], v[0:15]
    v_mfma_f32_32x32x16_bf16 v[16:31], v[108:111], v[100:103], v[16:31]
    v_smfmac_f32_32x32x32_bf16 v[80:95], v[128:131], v[48:55], v136
    v_smfmac_f32_32x32x32_bf16 v[80:95], v[132:135], v[56:63], v136
    s_nop 7
    s_setprio 1
    v_exp_f32 v0, v0
    v_exp_f32 v1, v1
    v_exp_f32 v2, v2
    v_exp_f32 v3, v3
    v_exp_f32 v4, v4
    v_exp_f32 v5, v5
    v_exp_f32 v6, v6
    v_exp_f32 v7, v7
    v_exp_f32 v8, v8
    v_exp_f32 v9, v9
    v_exp_f32 v10, v10
    v_exp_f32 v11, v11
    v_exp_f32 v12, v12
    v_exp_f32 v13, v13
    v_exp_f32 v14, v14
    v_exp_f32 v15, v15
    v_exp_f32 v16, v16
    v_exp_f32 v17, v17
    v_exp_f32 v18, v18
    v_exp_f32 v19, v19
    v_exp_f32 v20, v20
    v_exp_f32 v21, v21
    v_exp_f32 v22, v22
    v_exp_f32 v23, v23
    v_exp_f32 v24, v24
    v_exp_f32 v25, v25
    v_exp_f32 v26, v26
    v_exp_f32 v27, v27
    v_exp_f32 v28, v28
    v_exp_f32 v29, v29
    v_exp_f32 v30, v30
    v_exp_f32 v31, v31
    s_setprio 3
    s_waitcnt lgkmcnt(0)
    v_mfma_f32_32x32x4_2b_bf16 v[32:63], v[112:113], v[104:105], 4.0 cbsz:1 abid:1
    ds_read_b64 v[118:119], v139 offset:48640
    ds_read_b64 v[108:109], v137 offset:48640
    ds_read_b64 v[110:111], v137 offset:48648
    v_smfmac_f32_32x32x32_bf16 v[64:79], v[120:123], v[0:7], v136
    ds_read_b64_tr_b16 v[128:129], v145 offset:6400
    ds_read_b64_tr_b16 v[130:131], v145 offset:6560
    s_nop 3
    v_smfmac_f32_32x32x32_bf16 v[64:79], v[124:127], v[8:15], v136
    ds_read_b64_tr_b16 v[132:133], v145 offset:7040
    ds_read_b64_tr_b16 v[134:135], v145 offset:7200
    s_nop 4
    v_mfma_f32_32x32x16_bf16 v[32:47], v[114:117], v[96:99], v[32:47]
    v_mfma_f32_32x32x16_bf16 v[48:63], v[114:117], v[100:103], v[48:63]
    v_smfmac_f32_32x32x32_bf16 v[80:95], v[120:123], v[16:23], v136
    v_smfmac_f32_32x32x32_bf16 v[80:95], v[124:127], v[24:31], v136
    s_nop 7
    s_setprio 1
    v_exp_f32 v32, v32
    v_exp_f32 v33, v33
    v_exp_f32 v34, v34
    v_exp_f32 v35, v35
    v_exp_f32 v36, v36
    v_exp_f32 v37, v37
    v_exp_f32 v38, v38
    v_exp_f32 v39, v39
    v_exp_f32 v40, v40
    v_exp_f32 v41, v41
    v_exp_f32 v42, v42
    v_exp_f32 v43, v43
    v_exp_f32 v44, v44
    v_exp_f32 v45, v45
    v_exp_f32 v46, v46
    v_exp_f32 v47, v47
    v_exp_f32 v48, v48
    v_exp_f32 v49, v49
    v_exp_f32 v50, v50
    v_exp_f32 v51, v51
    v_exp_f32 v52, v52
    v_exp_f32 v53, v53
    v_exp_f32 v54, v54
    v_exp_f32 v55, v55
    v_exp_f32 v56, v56
    v_exp_f32 v57, v57
    v_exp_f32 v58, v58
    v_exp_f32 v59, v59
    v_exp_f32 v60, v60
    v_exp_f32 v61, v61
    v_exp_f32 v62, v62
    v_exp_f32 v63, v63
    s_setprio 3
    s_waitcnt lgkmcnt(0)
    v_mfma_f32_32x32x4_2b_bf16 v[0:31], v[118:119], v[104:105], 4.0 cbsz:1 abid:0
    ds_read_b64 v[114:115], v137 offset:49920
    ds_read_b64 v[116:117], v137 offset:49928
    v_smfmac_f32_32x32x32_bf16 v[64:79], v[128:131], v[32:39], v136
    ds_read_b64_tr_b16 v[120:121], v145 offset:7680
    ds_read_b64_tr_b16 v[122:123], v145 offset:7840
    s_nop 4
    v_smfmac_f32_32x32x32_bf16 v[64:79], v[132:135], v[40:47], v136
    ds_read_b64_tr_b16 v[124:125], v145 offset:8320
    ds_read_b64_tr_b16 v[126:127], v145 offset:8480
    s_nop 4
    v_mfma_f32_32x32x16_bf16 v[0:15], v[108:111], v[96:99], v[0:15]
    v_mfma_f32_32x32x16_bf16 v[16:31], v[108:111], v[100:103], v[16:31]
    v_smfmac_f32_32x32x32_bf16 v[80:95], v[128:131], v[48:55], v136
    v_smfmac_f32_32x32x32_bf16 v[80:95], v[132:135], v[56:63], v136
    s_nop 7
    s_setprio 1
    v_exp_f32 v0, v0
    v_exp_f32 v1, v1
    v_exp_f32 v2, v2
    v_exp_f32 v3, v3
    v_exp_f32 v4, v4
    v_exp_f32 v5, v5
    v_exp_f32 v6, v6
    v_exp_f32 v7, v7
    v_exp_f32 v8, v8
    v_exp_f32 v9, v9
    v_exp_f32 v10, v10
    v_exp_f32 v11, v11
    v_exp_f32 v12, v12
    v_exp_f32 v13, v13
    v_exp_f32 v14, v14
    v_exp_f32 v15, v15
    v_exp_f32 v16, v16
    v_exp_f32 v17, v17
    v_exp_f32 v18, v18
    v_exp_f32 v19, v19
    v_exp_f32 v20, v20
    v_exp_f32 v21, v21
    v_exp_f32 v22, v22
    v_exp_f32 v23, v23
    v_exp_f32 v24, v24
    v_exp_f32 v25, v25
    v_exp_f32 v26, v26
    v_exp_f32 v27, v27
    v_exp_f32 v28, v28
    v_exp_f32 v29, v29
    v_exp_f32 v30, v30
    v_exp_f32 v31, v31
    s_setprio 3
    s_waitcnt lgkmcnt(0)
    v_mfma_f32_32x32x4_2b_bf16 v[32:63], v[118:119], v[104:105], 4.0 cbsz:1 abid:1
    ds_read_b64 v[112:113], v139 offset:51200
    ds_read_b64 v[108:109], v137 offset:51200
    ds_read_b64 v[110:111], v137 offset:51208
    v_smfmac_f32_32x32x32_bf16 v[64:79], v[120:123], v[0:7], v136
    ds_read_b64_tr_b16 v[128:129], v145 offset:8960
    ds_read_b64_tr_b16 v[130:131], v145 offset:9120
    s_nop 3
    v_smfmac_f32_32x32x32_bf16 v[64:79], v[124:127], v[8:15], v136
    ds_read_b64_tr_b16 v[132:133], v145 offset:9600
    ds_read_b64_tr_b16 v[134:135], v145 offset:9760
    s_nop 4
    v_mfma_f32_32x32x16_bf16 v[32:47], v[114:117], v[96:99], v[32:47]
    v_mfma_f32_32x32x16_bf16 v[48:63], v[114:117], v[100:103], v[48:63]
    v_smfmac_f32_32x32x32_bf16 v[80:95], v[120:123], v[16:23], v136
    v_smfmac_f32_32x32x32_bf16 v[80:95], v[124:127], v[24:31], v136
    s_nop 7
    s_setprio 1
    v_exp_f32 v32, v32
    v_exp_f32 v33, v33
    v_exp_f32 v34, v34
    v_exp_f32 v35, v35
    v_exp_f32 v36, v36
    v_exp_f32 v37, v37
    v_exp_f32 v38, v38
    v_exp_f32 v39, v39
    v_exp_f32 v40, v40
    v_exp_f32 v41, v41
    v_exp_f32 v42, v42
    v_exp_f32 v43, v43
    v_exp_f32 v44, v44
    v_exp_f32 v45, v45
    v_exp_f32 v46, v46
    v_exp_f32 v47, v47
    v_exp_f32 v48, v48
    v_exp_f32 v49, v49
    v_exp_f32 v50, v50
    v_exp_f32 v51, v51
    v_exp_f32 v52, v52
    v_exp_f32 v53, v53
    v_exp_f32 v54, v54
    v_exp_f32 v55, v55
    v_exp_f32 v56, v56
    v_exp_f32 v57, v57
    v_exp_f32 v58, v58
    v_exp_f32 v59, v59
    v_exp_f32 v60, v60
    v_exp_f32 v61, v61
    v_exp_f32 v62, v62
    v_exp_f32 v63, v63
    s_setprio 3
    s_waitcnt lgkmcnt(0)
    v_mfma_f32_32x32x4_2b_bf16 v[0:31], v[112:113], v[104:105], 4.0 cbsz:1 abid:0
    ds_read_b64 v[114:115], v137 offset:52480
    ds_read_b64 v[116:117], v137 offset:52488
    v_smfmac_f32_32x32x32_bf16 v[64:79], v[128:131], v[32:39], v136
    ds_read_b64_tr_b16 v[120:121], v146 offset:0
    ds_read_b64_tr_b16 v[122:123], v146 offset:160
    s_nop 4
    v_smfmac_f32_32x32x32_bf16 v[64:79], v[132:135], v[40:47], v136
    ds_read_b64_tr_b16 v[124:125], v146 offset:640
    ds_read_b64_tr_b16 v[126:127], v146 offset:800
    s_nop 4
    v_mfma_f32_32x32x16_bf16 v[0:15], v[108:111], v[96:99], v[0:15]
    v_mfma_f32_32x32x16_bf16 v[16:31], v[108:111], v[100:103], v[16:31]
    v_smfmac_f32_32x32x32_bf16 v[80:95], v[128:131], v[48:55], v136
    v_smfmac_f32_32x32x32_bf16 v[80:95], v[132:135], v[56:63], v136
    s_nop 7
    s_setprio 1
    v_exp_f32 v0, v0
    v_exp_f32 v1, v1
    v_exp_f32 v2, v2
    v_exp_f32 v3, v3
    v_exp_f32 v4, v4
    v_exp_f32 v5, v5
    v_exp_f32 v6, v6
    v_exp_f32 v7, v7
    v_exp_f32 v8, v8
    v_exp_f32 v9, v9
    v_exp_f32 v10, v10
    v_exp_f32 v11, v11
    v_exp_f32 v12, v12
    v_exp_f32 v13, v13
    v_exp_f32 v14, v14
    v_exp_f32 v15, v15
    v_exp_f32 v16, v16
    v_exp_f32 v17, v17
    v_exp_f32 v18, v18
    v_exp_f32 v19, v19
    v_exp_f32 v20, v20
    v_exp_f32 v21, v21
    v_exp_f32 v22, v22
    v_exp_f32 v23, v23
    v_exp_f32 v24, v24
    v_exp_f32 v25, v25
    v_exp_f32 v26, v26
    v_exp_f32 v27, v27
    v_exp_f32 v28, v28
    v_exp_f32 v29, v29
    v_exp_f32 v30, v30
    v_exp_f32 v31, v31
    s_setprio 3
    s_waitcnt lgkmcnt(0)
    v_mfma_f32_32x32x4_2b_bf16 v[32:63], v[112:113], v[104:105], 4.0 cbsz:1 abid:1
    ds_read_b64 v[118:119], v139 offset:53760
    ds_read_b64 v[108:109], v137 offset:53760
    ds_read_b64 v[110:111], v137 offset:53768
    v_smfmac_f32_32x32x32_bf16 v[64:79], v[120:123], v[0:7], v136
    ds_read_b64_tr_b16 v[128:129], v146 offset:1280
    ds_read_b64_tr_b16 v[130:131], v146 offset:1440
    s_nop 3
    v_smfmac_f32_32x32x32_bf16 v[64:79], v[124:127], v[8:15], v136
    ds_read_b64_tr_b16 v[132:133], v146 offset:1920
    ds_read_b64_tr_b16 v[134:135], v146 offset:2080
    s_nop 4
    v_mfma_f32_32x32x16_bf16 v[32:47], v[114:117], v[96:99], v[32:47]
    v_mfma_f32_32x32x16_bf16 v[48:63], v[114:117], v[100:103], v[48:63]
    v_smfmac_f32_32x32x32_bf16 v[80:95], v[120:123], v[16:23], v136
    v_smfmac_f32_32x32x32_bf16 v[80:95], v[124:127], v[24:31], v136
    s_nop 7
    s_setprio 1
    v_exp_f32 v32, v32
    v_exp_f32 v33, v33
    v_exp_f32 v34, v34
    v_exp_f32 v35, v35
    v_exp_f32 v36, v36
    v_exp_f32 v37, v37
    v_exp_f32 v38, v38
    v_exp_f32 v39, v39
    v_exp_f32 v40, v40
    v_exp_f32 v41, v41
    v_exp_f32 v42, v42
    v_exp_f32 v43, v43
    v_exp_f32 v44, v44
    v_exp_f32 v45, v45
    v_exp_f32 v46, v46
    v_exp_f32 v47, v47
    v_exp_f32 v48, v48
    v_exp_f32 v49, v49
    v_exp_f32 v50, v50
    v_exp_f32 v51, v51
    v_exp_f32 v52, v52
    v_exp_f32 v53, v53
    v_exp_f32 v54, v54
    v_exp_f32 v55, v55
    v_exp_f32 v56, v56
    v_exp_f32 v57, v57
    v_exp_f32 v58, v58
    v_exp_f32 v59, v59
    v_exp_f32 v60, v60
    v_exp_f32 v61, v61
    v_exp_f32 v62, v62
    v_exp_f32 v63, v63
    s_setprio 3
    s_waitcnt lgkmcnt(0)
    v_mfma_f32_32x32x4_2b_bf16 v[0:31], v[118:119], v[104:105], 4.0 cbsz:1 abid:0
    ds_read_b64 v[114:115], v137 offset:55040
    ds_read_b64 v[116:117], v137 offset:55048
    v_smfmac_f32_32x32x32_bf16 v[64:79], v[128:131], v[32:39], v136
    ds_read_b64_tr_b16 v[120:121], v146 offset:2560
    ds_read_b64_tr_b16 v[122:123], v146 offset:2720
    s_nop 4
    v_smfmac_f32_32x32x32_bf16 v[64:79], v[132:135], v[40:47], v136
    ds_read_b64_tr_b16 v[124:125], v146 offset:3200
    ds_read_b64_tr_b16 v[126:127], v146 offset:3360
    s_nop 4
    v_mfma_f32_32x32x16_bf16 v[0:15], v[108:111], v[96:99], v[0:15]
    v_mfma_f32_32x32x16_bf16 v[16:31], v[108:111], v[100:103], v[16:31]
    v_smfmac_f32_32x32x32_bf16 v[80:95], v[128:131], v[48:55], v136
    v_smfmac_f32_32x32x32_bf16 v[80:95], v[132:135], v[56:63], v136
    s_nop 7
    s_setprio 1
    v_exp_f32 v0, v0
    v_exp_f32 v1, v1
    v_exp_f32 v2, v2
    v_exp_f32 v3, v3
    v_exp_f32 v4, v4
    v_exp_f32 v5, v5
    v_exp_f32 v6, v6
    v_exp_f32 v7, v7
    v_exp_f32 v8, v8
    v_exp_f32 v9, v9
    v_exp_f32 v10, v10
    v_exp_f32 v11, v11
    v_exp_f32 v12, v12
    v_exp_f32 v13, v13
    v_exp_f32 v14, v14
    v_exp_f32 v15, v15
    v_exp_f32 v16, v16
    v_exp_f32 v17, v17
    v_exp_f32 v18, v18
    v_exp_f32 v19, v19
    v_exp_f32 v20, v20
    v_exp_f32 v21, v21
    v_exp_f32 v22, v22
    v_exp_f32 v23, v23
    v_exp_f32 v24, v24
    v_exp_f32 v25, v25
    v_exp_f32 v26, v26
    v_exp_f32 v27, v27
    v_exp_f32 v28, v28
    v_exp_f32 v29, v29
    v_exp_f32 v30, v30
    v_exp_f32 v31, v31
    s_setprio 3
    s_waitcnt lgkmcnt(0)
    v_mfma_f32_32x32x4_2b_bf16 v[32:63], v[118:119], v[104:105], 4.0 cbsz:1 abid:1
    ds_read_b64 v[112:113], v139 offset:56320
    ds_read_b64 v[108:109], v137 offset:56320
    ds_read_b64 v[110:111], v137 offset:56328
    v_smfmac_f32_32x32x32_bf16 v[64:79], v[120:123], v[0:7], v136
    ds_read_b64_tr_b16 v[128:129], v146 offset:3840
    ds_read_b64_tr_b16 v[130:131], v146 offset:4000
    s_nop 3
    v_smfmac_f32_32x32x32_bf16 v[64:79], v[124:127], v[8:15], v136
    ds_read_b64_tr_b16 v[132:133], v146 offset:4480
    ds_read_b64_tr_b16 v[134:135], v146 offset:4640
    s_nop 4
    v_mfma_f32_32x32x16_bf16 v[32:47], v[114:117], v[96:99], v[32:47]
    v_mfma_f32_32x32x16_bf16 v[48:63], v[114:117], v[100:103], v[48:63]
    v_smfmac_f32_32x32x32_bf16 v[80:95], v[120:123], v[16:23], v136
    v_smfmac_f32_32x32x32_bf16 v[80:95], v[124:127], v[24:31], v136
    s_nop 7
    s_setprio 1
    v_exp_f32 v32, v32
    v_exp_f32 v33, v33
    v_exp_f32 v34, v34
    v_exp_f32 v35, v35
    v_exp_f32 v36, v36
    v_exp_f32 v37, v37
    v_exp_f32 v38, v38
    v_exp_f32 v39, v39
    v_exp_f32 v40, v40
    v_exp_f32 v41, v41
    v_exp_f32 v42, v42
    v_exp_f32 v43, v43
    v_exp_f32 v44, v44
    v_exp_f32 v45, v45
    v_exp_f32 v46, v46
    v_exp_f32 v47, v47
    v_exp_f32 v48, v48
    v_exp_f32 v49, v49
    v_exp_f32 v50, v50
    v_exp_f32 v51, v51
    v_exp_f32 v52, v52
    v_exp_f32 v53, v53
    v_exp_f32 v54, v54
    v_exp_f32 v55, v55
    v_exp_f32 v56, v56
    v_exp_f32 v57, v57
    v_exp_f32 v58, v58
    v_exp_f32 v59, v59
    v_exp_f32 v60, v60
    v_exp_f32 v61, v61
    v_exp_f32 v62, v62
    v_exp_f32 v63, v63
    s_setprio 3
    s_waitcnt lgkmcnt(0)
    v_mfma_f32_32x32x4_2b_bf16 v[0:31], v[112:113], v[104:105], 4.0 cbsz:1 abid:0
    ds_read_b64 v[114:115], v137 offset:57600
    ds_read_b64 v[116:117], v137 offset:57608
    v_smfmac_f32_32x32x32_bf16 v[64:79], v[128:131], v[32:39], v136
    ds_read_b64_tr_b16 v[120:121], v146 offset:5120
    ds_read_b64_tr_b16 v[122:123], v146 offset:5280
    s_nop 4
    v_smfmac_f32_32x32x32_bf16 v[64:79], v[132:135], v[40:47], v136
    ds_read_b64_tr_b16 v[124:125], v146 offset:5760
    ds_read_b64_tr_b16 v[126:127], v146 offset:5920
    s_nop 4
    v_mfma_f32_32x32x16_bf16 v[0:15], v[108:111], v[96:99], v[0:15]
    v_mfma_f32_32x32x16_bf16 v[16:31], v[108:111], v[100:103], v[16:31]
    v_smfmac_f32_32x32x32_bf16 v[80:95], v[128:131], v[48:55], v136
    v_smfmac_f32_32x32x32_bf16 v[80:95], v[132:135], v[56:63], v136
    s_nop 7
    s_setprio 1
    v_exp_f32 v0, v0
    v_exp_f32 v1, v1
    v_exp_f32 v2, v2
    v_exp_f32 v3, v3
    v_exp_f32 v4, v4
    v_exp_f32 v5, v5
    v_exp_f32 v6, v6
    v_exp_f32 v7, v7
    v_exp_f32 v8, v8
    v_exp_f32 v9, v9
    v_exp_f32 v10, v10
    v_exp_f32 v11, v11
    v_exp_f32 v12, v12
    v_exp_f32 v13, v13
    v_exp_f32 v14, v14
    v_exp_f32 v15, v15
    v_exp_f32 v16, v16
    v_exp_f32 v17, v17
    v_exp_f32 v18, v18
    v_exp_f32 v19, v19
    v_exp_f32 v20, v20
    v_exp_f32 v21, v21
    v_exp_f32 v22, v22
    v_exp_f32 v23, v23
    v_exp_f32 v24, v24
    v_exp_f32 v25, v25
    v_exp_f32 v26, v26
    v_exp_f32 v27, v27
    v_exp_f32 v28, v28
    v_exp_f32 v29, v29
    v_exp_f32 v30, v30
    v_exp_f32 v31, v31
    s_setprio 3
    s_waitcnt lgkmcnt(0)
    v_mfma_f32_32x32x4_2b_bf16 v[32:63], v[112:113], v[104:105], 4.0 cbsz:1 abid:1
    ds_read_b64 v[118:119], v139 offset:58880
    ds_read_b64 v[108:109], v137 offset:58880
    ds_read_b64 v[110:111], v137 offset:58888
    v_smfmac_f32_32x32x32_bf16 v[64:79], v[120:123], v[0:7], v136
    ds_read_b64_tr_b16 v[128:129], v146 offset:6400
    ds_read_b64_tr_b16 v[130:131], v146 offset:6560
    s_nop 3
    v_smfmac_f32_32x32x32_bf16 v[64:79], v[124:127], v[8:15], v136
    ds_read_b64_tr_b16 v[132:133], v146 offset:7040
    ds_read_b64_tr_b16 v[134:135], v146 offset:7200
    s_nop 4
    v_mfma_f32_32x32x16_bf16 v[32:47], v[114:117], v[96:99], v[32:47]
    v_mfma_f32_32x32x16_bf16 v[48:63], v[114:117], v[100:103], v[48:63]
    v_smfmac_f32_32x32x32_bf16 v[80:95], v[120:123], v[16:23], v136
    v_smfmac_f32_32x32x32_bf16 v[80:95], v[124:127], v[24:31], v136
    s_nop 7
    s_setprio 1
    v_exp_f32 v32, v32
    v_exp_f32 v33, v33
    v_exp_f32 v34, v34
    v_exp_f32 v35, v35
    v_exp_f32 v36, v36
    v_exp_f32 v37, v37
    v_exp_f32 v38, v38
    v_exp_f32 v39, v39
    v_exp_f32 v40, v40
    v_exp_f32 v41, v41
    v_exp_f32 v42, v42
    v_exp_f32 v43, v43
    v_exp_f32 v44, v44
    v_exp_f32 v45, v45
    v_exp_f32 v46, v46
    v_exp_f32 v47, v47
    v_exp_f32 v48, v48
    v_exp_f32 v49, v49
    v_exp_f32 v50, v50
    v_exp_f32 v51, v51
    v_exp_f32 v52, v52
    v_exp_f32 v53, v53
    v_exp_f32 v54, v54
    v_exp_f32 v55, v55
    v_exp_f32 v56, v56
    v_exp_f32 v57, v57
    v_exp_f32 v58, v58
    v_exp_f32 v59, v59
    v_exp_f32 v60, v60
    v_exp_f32 v61, v61
    v_exp_f32 v62, v62
    v_exp_f32 v63, v63
    s_setprio 3
    s_waitcnt lgkmcnt(0)
    v_mfma_f32_32x32x4_2b_bf16 v[0:31], v[118:119], v[104:105], 4.0 cbsz:1 abid:0
    ds_read_b64 v[114:115], v137 offset:60160
    ds_read_b64 v[116:117], v137 offset:60168
    v_smfmac_f32_32x32x32_bf16 v[64:79], v[128:131], v[32:39], v136
    ds_read_b64_tr_b16 v[120:121], v146 offset:7680
    ds_read_b64_tr_b16 v[122:123], v146 offset:7840
    s_nop 4
    v_smfmac_f32_32x32x32_bf16 v[64:79], v[132:135], v[40:47], v136
    ds_read_b64_tr_b16 v[124:125], v146 offset:8320
    ds_read_b64_tr_b16 v[126:127], v146 offset:8480
    s_nop 4
    v_mfma_f32_32x32x16_bf16 v[0:15], v[108:111], v[96:99], v[0:15]
    v_mfma_f32_32x32x16_bf16 v[16:31], v[108:111], v[100:103], v[16:31]
    v_smfmac_f32_32x32x32_bf16 v[80:95], v[128:131], v[48:55], v136
    v_smfmac_f32_32x32x32_bf16 v[80:95], v[132:135], v[56:63], v136
    s_nop 7
    s_setprio 1
    v_exp_f32 v0, v0
    v_exp_f32 v1, v1
    v_exp_f32 v2, v2
    v_exp_f32 v3, v3
    v_exp_f32 v4, v4
    v_exp_f32 v5, v5
    v_exp_f32 v6, v6
    v_exp_f32 v7, v7
    v_exp_f32 v8, v8
    v_exp_f32 v9, v9
    v_exp_f32 v10, v10
    v_exp_f32 v11, v11
    v_exp_f32 v12, v12
    v_exp_f32 v13, v13
    v_exp_f32 v14, v14
    v_exp_f32 v15, v15
    v_exp_f32 v16, v16
    v_exp_f32 v17, v17
    v_exp_f32 v18, v18
    v_exp_f32 v19, v19
    v_exp_f32 v20, v20
    v_exp_f32 v21, v21
    v_exp_f32 v22, v22
    v_exp_f32 v23, v23
    v_exp_f32 v24, v24
    v_exp_f32 v25, v25
    v_exp_f32 v26, v26
    v_exp_f32 v27, v27
    v_exp_f32 v28, v28
    v_exp_f32 v29, v29
    v_exp_f32 v30, v30
    v_exp_f32 v31, v31
    s_setprio 3
    s_waitcnt lgkmcnt(0)
    v_mfma_f32_32x32x4_2b_bf16 v[32:63], v[118:119], v[104:105], 4.0 cbsz:1 abid:1
    ds_read_b64 v[112:113], v140 offset:0
    ds_read_b64 v[108:109], v138 offset:0
    ds_read_b64 v[110:111], v138 offset:8
    v_smfmac_f32_32x32x32_bf16 v[64:79], v[120:123], v[0:7], v136
    ds_read_b64_tr_b16 v[128:129], v146 offset:8960
    ds_read_b64_tr_b16 v[130:131], v146 offset:9120
    s_nop 3
    v_smfmac_f32_32x32x32_bf16 v[64:79], v[124:127], v[8:15], v136
    ds_read_b64_tr_b16 v[132:133], v146 offset:9600
    ds_read_b64_tr_b16 v[134:135], v146 offset:9760
    s_nop 4
    v_mfma_f32_32x32x16_bf16 v[32:47], v[114:117], v[96:99], v[32:47]
    v_mfma_f32_32x32x16_bf16 v[48:63], v[114:117], v[100:103], v[48:63]
    v_smfmac_f32_32x32x32_bf16 v[80:95], v[120:123], v[16:23], v136
    v_smfmac_f32_32x32x32_bf16 v[80:95], v[124:127], v[24:31], v136
    s_nop 7
    s_setprio 1
    v_exp_f32 v32, v32
    v_exp_f32 v33, v33
    v_exp_f32 v34, v34
    v_exp_f32 v35, v35
    v_exp_f32 v36, v36
    v_exp_f32 v37, v37
    v_exp_f32 v38, v38
    v_exp_f32 v39, v39
    v_exp_f32 v40, v40
    v_exp_f32 v41, v41
    v_exp_f32 v42, v42
    v_exp_f32 v43, v43
    v_exp_f32 v44, v44
    v_exp_f32 v45, v45
    v_exp_f32 v46, v46
    v_exp_f32 v47, v47
    v_exp_f32 v48, v48
    v_exp_f32 v49, v49
    v_exp_f32 v50, v50
    v_exp_f32 v51, v51
    v_exp_f32 v52, v52
    v_exp_f32 v53, v53
    v_exp_f32 v54, v54
    v_exp_f32 v55, v55
    v_exp_f32 v56, v56
    v_exp_f32 v57, v57
    v_exp_f32 v58, v58
    v_exp_f32 v59, v59
    v_exp_f32 v60, v60
    v_exp_f32 v61, v61
    v_exp_f32 v62, v62
    v_exp_f32 v63, v63
    s_setprio 3
    s_waitcnt lgkmcnt(0)
    v_mfma_f32_32x32x4_2b_bf16 v[0:31], v[112:113], v[104:105], 4.0 cbsz:1 abid:0
    ds_read_b64 v[114:115], v138 offset:1280
    ds_read_b64 v[116:117], v138 offset:1288
    v_smfmac_f32_32x32x32_bf16 v[64:79], v[128:131], v[32:39], v136
    ds_read_b64_tr_b16 v[120:121], v147 offset:0
    ds_read_b64_tr_b16 v[122:123], v147 offset:160
    s_nop 4
    v_smfmac_f32_32x32x32_bf16 v[64:79], v[132:135], v[40:47], v136
    ds_read_b64_tr_b16 v[124:125], v147 offset:640
    ds_read_b64_tr_b16 v[126:127], v147 offset:800
    s_nop 4
    v_mfma_f32_32x32x16_bf16 v[0:15], v[108:111], v[96:99], v[0:15]
    v_mfma_f32_32x32x16_bf16 v[16:31], v[108:111], v[100:103], v[16:31]
    v_smfmac_f32_32x32x32_bf16 v[80:95], v[128:131], v[48:55], v136
    v_smfmac_f32_32x32x32_bf16 v[80:95], v[132:135], v[56:63], v136
    s_nop 7
    s_setprio 1
    v_exp_f32 v0, v0
    v_exp_f32 v1, v1
    v_exp_f32 v2, v2
    v_exp_f32 v3, v3
    v_exp_f32 v4, v4
    v_exp_f32 v5, v5
    v_exp_f32 v6, v6
    v_exp_f32 v7, v7
    v_exp_f32 v8, v8
    v_exp_f32 v9, v9
    v_exp_f32 v10, v10
    v_exp_f32 v11, v11
    v_exp_f32 v12, v12
    v_exp_f32 v13, v13
    v_exp_f32 v14, v14
    v_exp_f32 v15, v15
    v_exp_f32 v16, v16
    v_exp_f32 v17, v17
    v_exp_f32 v18, v18
    v_exp_f32 v19, v19
    v_exp_f32 v20, v20
    v_exp_f32 v21, v21
    v_exp_f32 v22, v22
    v_exp_f32 v23, v23
    v_exp_f32 v24, v24
    v_exp_f32 v25, v25
    v_exp_f32 v26, v26
    v_exp_f32 v27, v27
    v_exp_f32 v28, v28
    v_exp_f32 v29, v29
    v_exp_f32 v30, v30
    v_exp_f32 v31, v31
    s_setprio 3
    s_waitcnt lgkmcnt(0)
    v_mfma_f32_32x32x4_2b_bf16 v[32:63], v[112:113], v[104:105], 4.0 cbsz:1 abid:1
    ds_read_b64 v[118:119], v140 offset:2560
    ds_read_b64 v[108:109], v138 offset:2560
    ds_read_b64 v[110:111], v138 offset:2568
    v_smfmac_f32_32x32x32_bf16 v[64:79], v[120:123], v[0:7], v136
    ds_read_b64_tr_b16 v[128:129], v147 offset:1280
    ds_read_b64_tr_b16 v[130:131], v147 offset:1440
    s_nop 3
    v_smfmac_f32_32x32x32_bf16 v[64:79], v[124:127], v[8:15], v136
    ds_read_b64_tr_b16 v[132:133], v147 offset:1920
    ds_read_b64_tr_b16 v[134:135], v147 offset:2080
    s_nop 4
    v_mfma_f32_32x32x16_bf16 v[32:47], v[114:117], v[96:99], v[32:47]
    v_mfma_f32_32x32x16_bf16 v[48:63], v[114:117], v[100:103], v[48:63]
    v_smfmac_f32_32x32x32_bf16 v[80:95], v[120:123], v[16:23], v136
    v_smfmac_f32_32x32x32_bf16 v[80:95], v[124:127], v[24:31], v136
    s_nop 7
    s_setprio 1
    v_exp_f32 v32, v32
    v_exp_f32 v33, v33
    v_exp_f32 v34, v34
    v_exp_f32 v35, v35
    v_exp_f32 v36, v36
    v_exp_f32 v37, v37
    v_exp_f32 v38, v38
    v_exp_f32 v39, v39
    v_exp_f32 v40, v40
    v_exp_f32 v41, v41
    v_exp_f32 v42, v42
    v_exp_f32 v43, v43
    v_exp_f32 v44, v44
    v_exp_f32 v45, v45
    v_exp_f32 v46, v46
    v_exp_f32 v47, v47
    v_exp_f32 v48, v48
    v_exp_f32 v49, v49
    v_exp_f32 v50, v50
    v_exp_f32 v51, v51
    v_exp_f32 v52, v52
    v_exp_f32 v53, v53
    v_exp_f32 v54, v54
    v_exp_f32 v55, v55
    v_exp_f32 v56, v56
    v_exp_f32 v57, v57
    v_exp_f32 v58, v58
    v_exp_f32 v59, v59
    v_exp_f32 v60, v60
    v_exp_f32 v61, v61
    v_exp_f32 v62, v62
    v_exp_f32 v63, v63
    s_setprio 3
    s_waitcnt lgkmcnt(0)
    v_mfma_f32_32x32x4_2b_bf16 v[0:31], v[118:119], v[104:105], 4.0 cbsz:1 abid:0
    ds_read_b64 v[114:115], v138 offset:3840
    ds_read_b64 v[116:117], v138 offset:3848
    v_smfmac_f32_32x32x32_bf16 v[64:79], v[128:131], v[32:39], v136
    ds_read_b64_tr_b16 v[120:121], v147 offset:2560
    ds_read_b64_tr_b16 v[122:123], v147 offset:2720
    s_nop 4
    v_smfmac_f32_32x32x32_bf16 v[64:79], v[132:135], v[40:47], v136
    ds_read_b64_tr_b16 v[124:125], v147 offset:3200
    ds_read_b64_tr_b16 v[126:127], v147 offset:3360
    s_nop 4
    v_mfma_f32_32x32x16_bf16 v[0:15], v[108:111], v[96:99], v[0:15]
    v_mfma_f32_32x32x16_bf16 v[16:31], v[108:111], v[100:103], v[16:31]
    v_smfmac_f32_32x32x32_bf16 v[80:95], v[128:131], v[48:55], v136
    v_smfmac_f32_32x32x32_bf16 v[80:95], v[132:135], v[56:63], v136
    s_nop 7
    s_waitcnt vmcnt(0)
    s_barrier
    s_setprio 1
    v_exp_f32 v0, v0
    v_exp_f32 v1, v1
    v_exp_f32 v2, v2
    v_exp_f32 v3, v3
    v_exp_f32 v4, v4
    v_exp_f32 v5, v5
    v_exp_f32 v6, v6
    v_exp_f32 v7, v7
    v_exp_f32 v8, v8
    v_exp_f32 v9, v9
    v_exp_f32 v10, v10
    v_exp_f32 v11, v11
    v_exp_f32 v12, v12
    v_exp_f32 v13, v13
    v_exp_f32 v14, v14
    v_exp_f32 v15, v15
    v_exp_f32 v16, v16
    v_exp_f32 v17, v17
    v_exp_f32 v18, v18
    v_exp_f32 v19, v19
    v_exp_f32 v20, v20
    v_exp_f32 v21, v21
    v_exp_f32 v22, v22
    v_exp_f32 v23, v23
    v_exp_f32 v24, v24
    v_exp_f32 v25, v25
    v_exp_f32 v26, v26
    v_exp_f32 v27, v27
    v_exp_f32 v28, v28
    v_exp_f32 v29, v29
    v_exp_f32 v30, v30
    v_exp_f32 v31, v31
    s_setprio 3
    s_waitcnt lgkmcnt(0)
    v_mfma_f32_32x32x4_2b_bf16 v[32:63], v[118:119], v[104:105], 4.0 cbsz:1 abid:1
    ds_read_b64 v[112:113], v140 offset:5120
    ds_read_b64 v[108:109], v138 offset:5120
    ds_read_b64 v[110:111], v138 offset:5128
    v_smfmac_f32_32x32x32_bf16 v[64:79], v[120:123], v[0:7], v136
    ds_read_b64_tr_b16 v[128:129], v147 offset:3840
    ds_read_b64_tr_b16 v[130:131], v147 offset:4000
    s_nop 3
    v_smfmac_f32_32x32x32_bf16 v[64:79], v[124:127], v[8:15], v136
    ds_read_b64_tr_b16 v[132:133], v147 offset:4480
    ds_read_b64_tr_b16 v[134:135], v147 offset:4640
    s_nop 4
    v_mfma_f32_32x32x16_bf16 v[32:47], v[114:117], v[96:99], v[32:47]
    v_mfma_f32_32x32x16_bf16 v[48:63], v[114:117], v[100:103], v[48:63]
    v_smfmac_f32_32x32x32_bf16 v[80:95], v[120:123], v[16:23], v136
    v_smfmac_f32_32x32x32_bf16 v[80:95], v[124:127], v[24:31], v136
    s_nop 7
    s_setprio 1
    v_exp_f32 v32, v32
    v_exp_f32 v33, v33
    v_exp_f32 v34, v34
    v_exp_f32 v35, v35
    v_exp_f32 v36, v36
    v_exp_f32 v37, v37
    v_exp_f32 v38, v38
    v_exp_f32 v39, v39
    v_exp_f32 v40, v40
    v_exp_f32 v41, v41
    v_exp_f32 v42, v42
    v_exp_f32 v43, v43
    v_exp_f32 v44, v44
    v_exp_f32 v45, v45
    v_exp_f32 v46, v46
    v_exp_f32 v47, v47
    v_exp_f32 v48, v48
    v_exp_f32 v49, v49
    v_exp_f32 v50, v50
    v_exp_f32 v51, v51
    v_exp_f32 v52, v52
    v_exp_f32 v53, v53
    v_exp_f32 v54, v54
    v_exp_f32 v55, v55
    v_exp_f32 v56, v56
    v_exp_f32 v57, v57
    v_exp_f32 v58, v58
    v_exp_f32 v59, v59
    v_exp_f32 v60, v60
    v_exp_f32 v61, v61
    v_exp_f32 v62, v62
    v_exp_f32 v63, v63
    s_setprio 3
    s_waitcnt lgkmcnt(0)
    v_mfma_f32_32x32x4_2b_bf16 v[0:31], v[112:113], v[104:105], 4.0 cbsz:1 abid:0
    ds_read_b64 v[114:115], v138 offset:6400
    ds_read_b64 v[116:117], v138 offset:6408
    v_smfmac_f32_32x32x32_bf16 v[64:79], v[128:131], v[32:39], v136
    ds_read_b64_tr_b16 v[120:121], v147 offset:5120
    ds_read_b64_tr_b16 v[122:123], v147 offset:5280
    s_nop 4
    v_smfmac_f32_32x32x32_bf16 v[64:79], v[132:135], v[40:47], v136
    ds_read_b64_tr_b16 v[124:125], v147 offset:5760
    ds_read_b64_tr_b16 v[126:127], v147 offset:5920
    s_nop 4
    v_mfma_f32_32x32x16_bf16 v[0:15], v[108:111], v[96:99], v[0:15]
    v_mfma_f32_32x32x16_bf16 v[16:31], v[108:111], v[100:103], v[16:31]
    v_smfmac_f32_32x32x32_bf16 v[80:95], v[128:131], v[48:55], v136
    v_smfmac_f32_32x32x32_bf16 v[80:95], v[132:135], v[56:63], v136
    s_nop 7
    s_setprio 1
    v_exp_f32 v0, v0
    v_exp_f32 v1, v1
    v_exp_f32 v2, v2
    v_exp_f32 v3, v3
    v_exp_f32 v4, v4
    v_exp_f32 v5, v5
    v_exp_f32 v6, v6
    v_exp_f32 v7, v7
    v_exp_f32 v8, v8
    v_exp_f32 v9, v9
    v_exp_f32 v10, v10
    v_exp_f32 v11, v11
    v_exp_f32 v12, v12
    v_exp_f32 v13, v13
    v_exp_f32 v14, v14
    v_exp_f32 v15, v15
    v_exp_f32 v16, v16
    v_exp_f32 v17, v17
    v_exp_f32 v18, v18
    v_exp_f32 v19, v19
    v_exp_f32 v20, v20
    v_exp_f32 v21, v21
    v_exp_f32 v22, v22
    v_exp_f32 v23, v23
    v_exp_f32 v24, v24
    v_exp_f32 v25, v25
    v_exp_f32 v26, v26
    v_exp_f32 v27, v27
    v_exp_f32 v28, v28
    v_exp_f32 v29, v29
    v_exp_f32 v30, v30
    v_exp_f32 v31, v31
    s_setprio 3
    s_waitcnt lgkmcnt(0)
    v_mfma_f32_32x32x4_2b_bf16 v[32:63], v[112:113], v[104:105], 4.0 cbsz:1 abid:1
    ds_read_b64 v[118:119], v140 offset:7680
    ds_read_b64 v[108:109], v138 offset:7680
    ds_read_b64 v[110:111], v138 offset:7688
    v_smfmac_f32_32x32x32_bf16 v[64:79], v[120:123], v[0:7], v136
    ds_read_b64_tr_b16 v[128:129], v147 offset:6400
    ds_read_b64_tr_b16 v[130:131], v147 offset:6560
    s_nop 3
    v_smfmac_f32_32x32x32_bf16 v[64:79], v[124:127], v[8:15], v136
    ds_read_b64_tr_b16 v[132:133], v147 offset:7040
    ds_read_b64_tr_b16 v[134:135], v147 offset:7200
    s_nop 4
    v_mfma_f32_32x32x16_bf16 v[32:47], v[114:117], v[96:99], v[32:47]
    v_mfma_f32_32x32x16_bf16 v[48:63], v[114:117], v[100:103], v[48:63]
    v_smfmac_f32_32x32x32_bf16 v[80:95], v[120:123], v[16:23], v136
    v_smfmac_f32_32x32x32_bf16 v[80:95], v[124:127], v[24:31], v136
    s_nop 7
    s_setprio 1
    v_exp_f32 v32, v32
    v_exp_f32 v33, v33
    v_exp_f32 v34, v34
    v_exp_f32 v35, v35
    v_exp_f32 v36, v36
    v_exp_f32 v37, v37
    v_exp_f32 v38, v38
    v_exp_f32 v39, v39
    v_exp_f32 v40, v40
    v_exp_f32 v41, v41
    v_exp_f32 v42, v42
    v_exp_f32 v43, v43
    v_exp_f32 v44, v44
    v_exp_f32 v45, v45
    v_exp_f32 v46, v46
    v_exp_f32 v47, v47
    v_exp_f32 v48, v48
    v_exp_f32 v49, v49
    v_exp_f32 v50, v50
    v_exp_f32 v51, v51
    v_exp_f32 v52, v52
    v_exp_f32 v53, v53
    v_exp_f32 v54, v54
    v_exp_f32 v55, v55
    v_exp_f32 v56, v56
    v_exp_f32 v57, v57
    v_exp_f32 v58, v58
    v_exp_f32 v59, v59
    v_exp_f32 v60, v60
    v_exp_f32 v61, v61
    v_exp_f32 v62, v62
    v_exp_f32 v63, v63
    s_setprio 3
    s_waitcnt lgkmcnt(0)
    v_mfma_f32_32x32x4_2b_bf16 v[0:31], v[118:119], v[104:105], 4.0 cbsz:1 abid:0
    ds_read_b64 v[114:115], v138 offset:8960
    ds_read_b64 v[116:117], v138 offset:8968
    v_smfmac_f32_32x32x32_bf16 v[64:79], v[128:131], v[32:39], v136
    ds_read_b64_tr_b16 v[120:121], v147 offset:7680
    ds_read_b64_tr_b16 v[122:123], v147 offset:7840
    s_nop 4
    v_smfmac_f32_32x32x32_bf16 v[64:79], v[132:135], v[40:47], v136
    ds_read_b64_tr_b16 v[124:125], v147 offset:8320
    ds_read_b64_tr_b16 v[126:127], v147 offset:8480
    s_nop 4
    v_mfma_f32_32x32x16_bf16 v[0:15], v[108:111], v[96:99], v[0:15]
    v_mfma_f32_32x32x16_bf16 v[16:31], v[108:111], v[100:103], v[16:31]
    v_smfmac_f32_32x32x32_bf16 v[80:95], v[128:131], v[48:55], v136
    v_smfmac_f32_32x32x32_bf16 v[80:95], v[132:135], v[56:63], v136
    s_nop 7
    s_setprio 1
    v_exp_f32 v0, v0
    v_exp_f32 v1, v1
    v_exp_f32 v2, v2
    v_exp_f32 v3, v3
    v_exp_f32 v4, v4
    v_exp_f32 v5, v5
    v_exp_f32 v6, v6
    v_exp_f32 v7, v7
    v_exp_f32 v8, v8
    v_exp_f32 v9, v9
    v_exp_f32 v10, v10
    v_exp_f32 v11, v11
    v_exp_f32 v12, v12
    v_exp_f32 v13, v13
    v_exp_f32 v14, v14
    v_exp_f32 v15, v15
    v_exp_f32 v16, v16
    v_exp_f32 v17, v17
    v_exp_f32 v18, v18
    v_exp_f32 v19, v19
    v_exp_f32 v20, v20
    v_exp_f32 v21, v21
    v_exp_f32 v22, v22
    v_exp_f32 v23, v23
    v_exp_f32 v24, v24
    v_exp_f32 v25, v25
    v_exp_f32 v26, v26
    v_exp_f32 v27, v27
    v_exp_f32 v28, v28
    v_exp_f32 v29, v29
    v_exp_f32 v30, v30
    v_exp_f32 v31, v31
    s_setprio 3
    s_waitcnt lgkmcnt(0)
    v_mfma_f32_32x32x4_2b_bf16 v[32:63], v[118:119], v[104:105], 4.0 cbsz:1 abid:1
    ds_read_b64 v[112:113], v139 offset:0
    ds_read_b64 v[108:109], v137 offset:0
    ds_read_b64 v[110:111], v137 offset:8
    v_smfmac_f32_32x32x32_bf16 v[64:79], v[120:123], v[0:7], v136
    ds_read_b64_tr_b16 v[128:129], v147 offset:8960
    ds_read_b64_tr_b16 v[130:131], v147 offset:9120
    s_nop 3
    v_smfmac_f32_32x32x32_bf16 v[64:79], v[124:127], v[8:15], v136
    ds_read_b64_tr_b16 v[132:133], v147 offset:9600
    ds_read_b64_tr_b16 v[134:135], v147 offset:9760
    s_nop 4
    v_mfma_f32_32x32x16_bf16 v[32:47], v[114:117], v[96:99], v[32:47]
    v_mfma_f32_32x32x16_bf16 v[48:63], v[114:117], v[100:103], v[48:63]
    v_smfmac_f32_32x32x32_bf16 v[80:95], v[120:123], v[16:23], v136
    v_smfmac_f32_32x32x32_bf16 v[80:95], v[124:127], v[24:31], v136
    s_nop 7
    s_setprio 1
    v_exp_f32 v32, v32
    v_exp_f32 v33, v33
    v_exp_f32 v34, v34
    v_exp_f32 v35, v35
    v_exp_f32 v36, v36
    v_exp_f32 v37, v37
    v_exp_f32 v38, v38
    v_exp_f32 v39, v39
    v_exp_f32 v40, v40
    v_exp_f32 v41, v41
    v_exp_f32 v42, v42
    v_exp_f32 v43, v43
    v_exp_f32 v44, v44
    v_exp_f32 v45, v45
    v_exp_f32 v46, v46
    v_exp_f32 v47, v47
    v_exp_f32 v48, v48
    v_exp_f32 v49, v49
    v_exp_f32 v50, v50
    v_exp_f32 v51, v51
    v_exp_f32 v52, v52
    v_exp_f32 v53, v53
    v_exp_f32 v54, v54
    v_exp_f32 v55, v55
    v_exp_f32 v56, v56
    v_exp_f32 v57, v57
    v_exp_f32 v58, v58
    v_exp_f32 v59, v59
    v_exp_f32 v60, v60
    v_exp_f32 v61, v61
    v_exp_f32 v62, v62
    v_exp_f32 v63, v63
    s_setprio 3
    s_waitcnt lgkmcnt(0)
    v_mfma_f32_32x32x4_2b_bf16 v[0:31], v[112:113], v[104:105], 4.0 cbsz:1 abid:0
    ds_read_b64 v[114:115], v137 offset:1280
    ds_read_b64 v[116:117], v137 offset:1288
    v_smfmac_f32_32x32x32_bf16 v[64:79], v[128:131], v[32:39], v136
    ds_read_b64_tr_b16 v[120:121], v141 offset:0
    ds_read_b64_tr_b16 v[122:123], v141 offset:160
    s_nop 4
    v_smfmac_f32_32x32x32_bf16 v[64:79], v[132:135], v[40:47], v136
    ds_read_b64_tr_b16 v[124:125], v141 offset:640
    ds_read_b64_tr_b16 v[126:127], v141 offset:800
    s_nop 4
    v_mfma_f32_32x32x16_bf16 v[0:15], v[108:111], v[96:99], v[0:15]
    ds_read_b64 v[164:165], v137 offset:6400
    ds_read_b64 v[166:167], v137 offset:6408
    v_mfma_f32_32x32x16_bf16 v[16:31], v[108:111], v[100:103], v[16:31]
    ds_read_b64_tr_b16 v[184:185], v141 offset:5120
    ds_read_b64_tr_b16 v[186:187], v141 offset:5280
    v_smfmac_f32_32x32x32_bf16 v[80:95], v[128:131], v[48:55], v136
    ds_read_b64_tr_b16 v[188:189], v141 offset:5760
    ds_read_b64_tr_b16 v[190:191], v141 offset:5920
    v_smfmac_f32_32x32x32_bf16 v[80:95], v[132:135], v[56:63], v136
    s_nop 7
    s_setprio 1
    v_exp_f32 v0, v0
    v_exp_f32 v1, v1
    v_exp_f32 v2, v2
    v_exp_f32 v3, v3
    v_exp_f32 v4, v4
    v_exp_f32 v5, v5
    v_exp_f32 v6, v6
    v_exp_f32 v7, v7
    v_exp_f32 v8, v8
    v_exp_f32 v9, v9
    v_exp_f32 v10, v10
    v_exp_f32 v11, v11
    v_exp_f32 v12, v12
    v_exp_f32 v13, v13
    v_exp_f32 v14, v14
    v_exp_f32 v15, v15
    v_exp_f32 v16, v16
    v_exp_f32 v17, v17
    v_exp_f32 v18, v18
    v_exp_f32 v19, v19
    v_exp_f32 v20, v20
    v_exp_f32 v21, v21
    v_exp_f32 v22, v22
    v_exp_f32 v23, v23
    v_exp_f32 v24, v24
    v_exp_f32 v25, v25
    v_exp_f32 v26, v26
    v_exp_f32 v27, v27
    v_exp_f32 v28, v28
    v_exp_f32 v29, v29
    v_exp_f32 v30, v30
    v_exp_f32 v31, v31
    s_setprio 3
    s_waitcnt lgkmcnt(0)
    v_mfma_f32_32x32x4_2b_bf16 v[32:63], v[112:113], v[104:105], 4.0 cbsz:1 abid:1
    ds_read_b64 v[118:119], v139 offset:2560
    ds_read_b64 v[108:109], v137 offset:2560
    ds_read_b64 v[110:111], v137 offset:2568
    v_smfmac_f32_32x32x32_bf16 v[64:79], v[120:123], v[0:7], v136
    ds_read_b64_tr_b16 v[128:129], v141 offset:1280
    ds_read_b64_tr_b16 v[130:131], v141 offset:1440
    s_nop 3
    v_smfmac_f32_32x32x32_bf16 v[64:79], v[124:127], v[8:15], v136
    ds_read_b64_tr_b16 v[132:133], v141 offset:1920
    ds_read_b64_tr_b16 v[134:135], v141 offset:2080
    s_nop 4
    v_mfma_f32_32x32x16_bf16 v[32:47], v[114:117], v[96:99], v[32:47]
    ds_read_b64 v[180:181], v139 offset:7680
    ds_read_b64 v[168:169], v137 offset:7680
    v_mfma_f32_32x32x16_bf16 v[48:63], v[114:117], v[100:103], v[48:63]
    ds_read_b64 v[170:171], v137 offset:7688
    ds_read_b64_tr_b16 v[192:193], v141 offset:6400
    v_smfmac_f32_32x32x32_bf16 v[80:95], v[120:123], v[16:23], v136
    ds_read_b64_tr_b16 v[194:195], v141 offset:6560
    ds_read_b64_tr_b16 v[196:197], v141 offset:7040
    v_smfmac_f32_32x32x32_bf16 v[80:95], v[124:127], v[24:31], v136
    s_nop 7
    s_setprio 1
    v_exp_f32 v32, v32
    v_exp_f32 v33, v33
    v_exp_f32 v34, v34
    v_exp_f32 v35, v35
    v_exp_f32 v36, v36
    v_exp_f32 v37, v37
    v_exp_f32 v38, v38
    v_exp_f32 v39, v39
    v_exp_f32 v40, v40
    v_exp_f32 v41, v41
    v_exp_f32 v42, v42
    v_exp_f32 v43, v43
    v_exp_f32 v44, v44
    v_exp_f32 v45, v45
    v_exp_f32 v46, v46
    v_exp_f32 v47, v47
    v_exp_f32 v48, v48
    v_exp_f32 v49, v49
    v_exp_f32 v50, v50
    v_exp_f32 v51, v51
    v_exp_f32 v52, v52
    v_exp_f32 v53, v53
    v_exp_f32 v54, v54
    v_exp_f32 v55, v55
    v_exp_f32 v56, v56
    v_exp_f32 v57, v57
    v_exp_f32 v58, v58
    v_exp_f32 v59, v59
    v_exp_f32 v60, v60
    v_exp_f32 v61, v61
    v_exp_f32 v62, v62
    v_exp_f32 v63, v63
    s_setprio 3
    s_waitcnt lgkmcnt(0)
    v_mfma_f32_32x32x4_2b_bf16 v[0:31], v[118:119], v[104:105], 4.0 cbsz:1 abid:0
    ds_read_b64 v[114:115], v137 offset:3840
    ds_read_b64 v[116:117], v137 offset:3848
    v_smfmac_f32_32x32x32_bf16 v[64:79], v[128:131], v[32:39], v136
    ds_read_b64_tr_b16 v[120:121], v141 offset:2560
    ds_read_b64_tr_b16 v[122:123], v141 offset:2720
    s_nop 4
    v_smfmac_f32_32x32x32_bf16 v[64:79], v[132:135], v[40:47], v136
    ds_read_b64_tr_b16 v[124:125], v141 offset:3200
    ds_read_b64_tr_b16 v[126:127], v141 offset:3360
    s_nop 4
    v_mfma_f32_32x32x16_bf16 v[0:15], v[108:111], v[96:99], v[0:15]
    ds_read_b64_tr_b16 v[198:199], v141 offset:7200
    ds_read_b64 v[172:173], v137 offset:8960
    v_mfma_f32_32x32x16_bf16 v[16:31], v[108:111], v[100:103], v[16:31]
    ds_read_b64 v[174:175], v137 offset:8968
    ds_read_b64_tr_b16 v[200:201], v141 offset:7680
    v_smfmac_f32_32x32x32_bf16 v[80:95], v[128:131], v[48:55], v136
    ds_read_b64_tr_b16 v[202:203], v141 offset:7840
    ds_read_b64_tr_b16 v[204:205], v141 offset:8320
    v_smfmac_f32_32x32x32_bf16 v[80:95], v[132:135], v[56:63], v136
    s_nop 7
    s_setprio 1
    v_exp_f32 v0, v0
    v_exp_f32 v1, v1
    v_exp_f32 v2, v2
    v_exp_f32 v3, v3
    v_exp_f32 v4, v4
    v_exp_f32 v5, v5
    v_exp_f32 v6, v6
    v_exp_f32 v7, v7
    v_exp_f32 v8, v8
    v_exp_f32 v9, v9
    v_exp_f32 v10, v10
    v_exp_f32 v11, v11
    v_exp_f32 v12, v12
    v_exp_f32 v13, v13
    v_exp_f32 v14, v14
    v_exp_f32 v15, v15
    v_exp_f32 v16, v16
    v_exp_f32 v17, v17
    v_exp_f32 v18, v18
    v_exp_f32 v19, v19
    v_exp_f32 v20, v20
    v_exp_f32 v21, v21
    v_exp_f32 v22, v22
    v_exp_f32 v23, v23
    v_exp_f32 v24, v24
    v_exp_f32 v25, v25
    v_exp_f32 v26, v26
    v_exp_f32 v27, v27
    v_exp_f32 v28, v28
    v_exp_f32 v29, v29
    v_exp_f32 v30, v30
    v_exp_f32 v31, v31
    s_setprio 3
    s_waitcnt lgkmcnt(0)
    v_mfma_f32_32x32x4_2b_bf16 v[32:63], v[118:119], v[104:105], 4.0 cbsz:1 abid:1
    ds_read_b64 v[112:113], v139 offset:5120
    ds_read_b64 v[108:109], v137 offset:5120
    ds_read_b64 v[110:111], v137 offset:5128
    v_smfmac_f32_32x32x32_bf16 v[64:79], v[120:123], v[0:7], v136
    ds_read_b64_tr_b16 v[128:129], v141 offset:3840
    ds_read_b64_tr_b16 v[130:131], v141 offset:4000
    s_nop 3
    v_smfmac_f32_32x32x32_bf16 v[64:79], v[124:127], v[8:15], v136
    ds_read_b64_tr_b16 v[132:133], v141 offset:4480
    ds_read_b64_tr_b16 v[134:135], v141 offset:4640
    s_nop 4
    v_mfma_f32_32x32x16_bf16 v[32:47], v[114:117], v[96:99], v[32:47]
    ds_read_b64_tr_b16 v[206:207], v141 offset:8480
    ds_read_b64_tr_b16 v[208:209], v141 offset:8960
    v_mfma_f32_32x32x16_bf16 v[48:63], v[114:117], v[100:103], v[48:63]
    ds_read_b64_tr_b16 v[210:211], v141 offset:9120
    ds_read_b64_tr_b16 v[212:213], v141 offset:9600
    v_smfmac_f32_32x32x32_bf16 v[80:95], v[120:123], v[16:23], v136
    ds_read_b64_tr_b16 v[214:215], v141 offset:9760
    v_smfmac_f32_32x32x32_bf16 v[80:95], v[124:127], v[24:31], v136
    s_nop 7
    s_setprio 1
    v_exp_f32 v32, v32
    v_exp_f32 v33, v33
    s_waitcnt lgkmcnt(0)
    v_exp_f32 v34, v34
    v_exp_f32 v35, v35
    v_exp_f32 v36, v36
    v_exp_f32 v37, v37
    v_mfma_f32_32x32x4_2b_bf16 v[0:31], v[112:113], v[104:105], 4.0 cbsz:1 abid:0
    v_exp_f32 v38, v38
    v_exp_f32 v39, v39
    v_exp_f32 v40, v40
    v_exp_f32 v41, v41
    v_exp_f32 v42, v42
    v_exp_f32 v43, v43
    v_exp_f32 v44, v44
    v_exp_f32 v45, v45
    v_smfmac_f32_32x32x32_bf16 v[64:79], v[128:131], v[32:39], v136
    v_exp_f32 v46, v46
    v_exp_f32 v47, v47
    v_exp_f32 v48, v48
    v_exp_f32 v49, v49
    v_smfmac_f32_32x32x32_bf16 v[64:79], v[132:135], v[40:47], v136
    v_exp_f32 v50, v50
    v_exp_f32 v51, v51
    v_exp_f32 v52, v52
    v_exp_f32 v53, v53
    v_mfma_f32_32x32x16_bf16 v[0:15], v[108:111], v[96:99], v[0:15]
    v_exp_f32 v54, v54
    v_exp_f32 v55, v55
    v_exp_f32 v56, v56
    v_exp_f32 v57, v57
    v_smfmac_f32_32x32x32_bf16 v[80:95], v[128:131], v[48:55], v136
    v_exp_f32 v58, v58
    v_exp_f32 v59, v59
    v_exp_f32 v60, v60
    v_exp_f32 v61, v61
    v_mfma_f32_32x32x16_bf16 v[16:31], v[108:111], v[100:103], v[16:31]
    v_exp_f32 v62, v62
    v_exp_f32 v63, v63
    v_exp_f32 v0, v0
    v_exp_f32 v1, v1
    v_smfmac_f32_32x32x32_bf16 v[80:95], v[132:135], v[56:63], v136
    s_waitcnt lgkmcnt(0)
    v_exp_f32 v2, v2
    v_exp_f32 v3, v3
    v_exp_f32 v4, v4
    v_exp_f32 v5, v5
    v_mfma_f32_32x32x4_2b_bf16 v[32:63], v[112:113], v[104:105], 4.0 cbsz:1 abid:1
    v_exp_f32 v6, v6
    v_exp_f32 v7, v7
    v_exp_f32 v8, v8
    v_exp_f32 v9, v9
    v_exp_f32 v10, v10
    v_exp_f32 v11, v11
    v_exp_f32 v12, v12
    v_exp_f32 v13, v13
    v_smfmac_f32_32x32x32_bf16 v[64:79], v[184:187], v[0:7], v136
    v_exp_f32 v14, v14
    v_exp_f32 v15, v15
    v_exp_f32 v16, v16
    v_exp_f32 v17, v17
    v_smfmac_f32_32x32x32_bf16 v[64:79], v[188:191], v[8:15], v136
    v_exp_f32 v18, v18
    v_exp_f32 v19, v19
    v_exp_f32 v20, v20
    v_exp_f32 v21, v21
    v_mfma_f32_32x32x16_bf16 v[32:47], v[164:167], v[96:99], v[32:47]
    v_exp_f32 v22, v22
    v_exp_f32 v23, v23
    v_exp_f32 v24, v24
    v_exp_f32 v25, v25
    v_smfmac_f32_32x32x32_bf16 v[80:95], v[184:187], v[16:23], v136
    v_exp_f32 v26, v26
    v_exp_f32 v27, v27
    v_exp_f32 v28, v28
    v_exp_f32 v29, v29
    v_mfma_f32_32x32x16_bf16 v[48:63], v[164:167], v[100:103], v[48:63]
    v_exp_f32 v30, v30
    v_exp_f32 v31, v31
    v_exp_f32 v32, v32
    v_exp_f32 v33, v33
    v_smfmac_f32_32x32x32_bf16 v[80:95], v[188:191], v[24:31], v136
    s_waitcnt lgkmcnt(0)
    v_exp_f32 v34, v34
    v_exp_f32 v35, v35
    v_exp_f32 v36, v36
    v_exp_f32 v37, v37
    v_mfma_f32_32x32x4_2b_bf16 v[0:31], v[180:181], v[104:105], 4.0 cbsz:1 abid:0
    v_exp_f32 v38, v38
    v_exp_f32 v39, v39
    v_exp_f32 v40, v40
    v_exp_f32 v41, v41
    v_exp_f32 v42, v42
    v_exp_f32 v43, v43
    v_exp_f32 v44, v44
    v_exp_f32 v45, v45
    v_smfmac_f32_32x32x32_bf16 v[64:79], v[192:195], v[32:39], v136
    v_exp_f32 v46, v46
    v_exp_f32 v47, v47
    v_exp_f32 v48, v48
    v_exp_f32 v49, v49
    v_smfmac_f32_32x32x32_bf16 v[64:79], v[196:199], v[40:47], v136
    v_exp_f32 v50, v50
    v_exp_f32 v51, v51
    v_exp_f32 v52, v52
    v_exp_f32 v53, v53
    v_mfma_f32_32x32x16_bf16 v[0:15], v[168:171], v[96:99], v[0:15]
    v_exp_f32 v54, v54
    v_exp_f32 v55, v55
    v_exp_f32 v56, v56
    v_exp_f32 v57, v57
    v_smfmac_f32_32x32x32_bf16 v[80:95], v[192:195], v[48:55], v136
    v_exp_f32 v58, v58
    v_exp_f32 v59, v59
    v_exp_f32 v60, v60
    v_exp_f32 v61, v61
    v_mfma_f32_32x32x16_bf16 v[16:31], v[168:171], v[100:103], v[16:31]
    v_exp_f32 v62, v62
    v_exp_f32 v63, v63
    v_exp_f32 v0, v0
    v_exp_f32 v1, v1
    v_smfmac_f32_32x32x32_bf16 v[80:95], v[196:199], v[56:63], v136
    s_waitcnt lgkmcnt(0)
    v_exp_f32 v2, v2
    v_exp_f32 v3, v3
    v_exp_f32 v4, v4
    v_exp_f32 v5, v5
    v_mfma_f32_32x32x4_2b_bf16 v[32:63], v[180:181], v[104:105], 4.0 cbsz:1 abid:1
    v_exp_f32 v6, v6
    v_exp_f32 v7, v7
    v_exp_f32 v8, v8
    v_exp_f32 v9, v9
    v_exp_f32 v10, v10
    v_exp_f32 v11, v11
    v_exp_f32 v12, v12
    v_exp_f32 v13, v13
    v_smfmac_f32_32x32x32_bf16 v[64:79], v[200:203], v[0:7], v136
    v_exp_f32 v14, v14
    v_exp_f32 v15, v15
    v_exp_f32 v16, v16
    v_exp_f32 v17, v17
    v_smfmac_f32_32x32x32_bf16 v[64:79], v[204:207], v[8:15], v136
    v_exp_f32 v18, v18
    v_exp_f32 v19, v19
    v_exp_f32 v20, v20
    v_exp_f32 v21, v21
    v_mfma_f32_32x32x16_bf16 v[32:47], v[172:175], v[96:99], v[32:47]
    v_exp_f32 v22, v22
    v_exp_f32 v23, v23
    v_exp_f32 v24, v24
    v_exp_f32 v25, v25
    v_smfmac_f32_32x32x32_bf16 v[80:95], v[200:203], v[16:23], v136
    v_exp_f32 v26, v26
    v_exp_f32 v27, v27
    v_exp_f32 v28, v28
    v_exp_f32 v29, v29
    v_mfma_f32_32x32x16_bf16 v[48:63], v[172:175], v[100:103], v[48:63]
    v_exp_f32 v30, v30
    v_exp_f32 v31, v31
    v_exp_f32 v32, v32
    v_exp_f32 v33, v33
    v_smfmac_f32_32x32x32_bf16 v[80:95], v[204:207], v[24:31], v136
    s_waitcnt lgkmcnt(0)
    v_exp_f32 v34, v34
    v_exp_f32 v35, v35
    v_exp_f32 v36, v36
    v_exp_f32 v37, v37
    v_exp_f32 v38, v38
    v_exp_f32 v39, v39
    v_exp_f32 v40, v40
    v_exp_f32 v41, v41
    v_smfmac_f32_32x32x32_bf16 v[64:79], v[208:211], v[32:39], v136
    v_exp_f32 v42, v42
    v_exp_f32 v43, v43
    v_exp_f32 v44, v44
    v_exp_f32 v45, v45
    v_exp_f32 v46, v46
    v_exp_f32 v47, v47
    v_exp_f32 v48, v48
    v_exp_f32 v49, v49
    v_smfmac_f32_32x32x32_bf16 v[64:79], v[212:215], v[40:47], v136
    v_exp_f32 v50, v50
    s_mul_i32 s42, s32, 2560
    v_exp_f32 v51, v51
    s_add_u32 s42, s42, 20480
    v_exp_f32 v52, v52
    v_add_u32 v8, s42, v162
    v_exp_f32 v53, v53
    v_add_u32 v10, s42, v149
    v_exp_f32 v54, v54
    v_exp_f32 v55, v55
    v_exp_f32 v56, v56
    v_exp_f32 v57, v57
    v_smfmac_f32_32x32x32_bf16 v[80:95], v[208:211], v[48:55], v136
    v_mov_b32 v0, v72
    v_mov_b32 v1, v72
    v_exp_f32 v58, v58
    v_exp_f32 v59, v59
    v_permlane32_swap_b32 v0, v1
    v_exp_f32 v60, v60
    v_rcp_f32 v4, v1
    v_exp_f32 v61, v61
    v_pk_mul_f32 v[64:65], v[64:65], v[4:5] op_sel_hi:[1,0]
    v_pk_mul_f32 v[66:67], v[66:67], v[4:5] op_sel_hi:[1,0]
    v_exp_f32 v62, v62
    v_pk_mul_f32 v[68:69], v[68:69], v[4:5] op_sel_hi:[1,0]
    v_pk_mul_f32 v[70:71], v[70:71], v[4:5] op_sel_hi:[1,0]
    v_exp_f32 v63, v63
    v_pk_mul_f32 v[72:73], v[72:73], v[4:5] op_sel_hi:[1,0]
    v_pk_mul_f32 v[74:75], v[74:75], v[4:5] op_sel_hi:[1,0]
    v_smfmac_f32_32x32x32_bf16 v[80:95], v[212:215], v[56:63], v136
    v_cvt_pk_bf16_f32 v16, v64, v65
    v_cvt_pk_bf16_f32 v17, v66, v67
    v_cvt_pk_bf16_f32 v18, v68, v69
    v_cvt_pk_bf16_f32 v19, v70, v71
    v_cvt_pk_bf16_f32 v20, v72, v73
    v_cvt_pk_bf16_f32 v21, v74, v75
    ds_write_b64 v8, v[16:17] offset:0
    ds_write_b64 v8, v[18:19] offset:16
    s_mov_b32 exec_hi, 0
    ds_write_b64 v8, v[20:21] offset:32
    s_mov_b32 exec_hi, -1
    ds_read_b128 v[12:15], v10
L_norm:
    v_mov_b32 v2, v88
    v_mov_b32 v3, v88
    s_nop 1
    v_permlane32_swap_b32 v2, v3
    s_nop 0
    v_rcp_f32 v6, v3
    s_nop 0
    v_pk_mul_f32 v[80:81], v[80:81], v[6:7] op_sel_hi:[1,0]
    v_pk_mul_f32 v[82:83], v[82:83], v[6:7] op_sel_hi:[1,0]
    v_pk_mul_f32 v[84:85], v[84:85], v[6:7] op_sel_hi:[1,0]
    v_pk_mul_f32 v[86:87], v[86:87], v[6:7] op_sel_hi:[1,0]
    v_pk_mul_f32 v[88:89], v[88:89], v[6:7] op_sel_hi:[1,0]
    v_pk_mul_f32 v[90:91], v[90:91], v[6:7] op_sel_hi:[1,0]
    s_waitcnt lgkmcnt(0)
    buffer_store_dwordx4 v[12:15], v149, s[20:23], s34 offen sc1 nt
    v_cvt_pk_bf16_f32 v32, v80, v81
    v_cvt_pk_bf16_f32 v33, v82, v83
    v_cvt_pk_bf16_f32 v34, v84, v85
    v_cvt_pk_bf16_f32 v35, v86, v87
    v_cvt_pk_bf16_f32 v36, v88, v89
    v_cvt_pk_bf16_f32 v37, v90, v91
    ds_write_b64 v8, v[32:33] offset:1280
    ds_write_b64 v8, v[34:35] offset:1296
    s_mov_b32 exec_hi, 0
    ds_write_b64 v8, v[36:37] offset:1312
    s_mov_b32 exec_hi, -1
    ds_read_b128 v[40:43], v10 offset:1024
    ds_read_b128 v[44:47], v10 offset:2048
    s_waitcnt lgkmcnt(1)
    buffer_store_dwordx4 v[40:43], v149, s[20:23], s34 offen offset:1024 sc1 nt
    s_waitcnt lgkmcnt(0)
    s_mov_b32 exec_hi, 0
    buffer_store_dwordx4 v[44:47], v149, s[20:23], s34 offen offset:2048 sc1 nt
    s_mov_b32 exec_hi, -1
    s_setprio 0
    s_mov_b32 s41, 0x71800000
    v_cmp_ngt_f32 vcc, s41, v1
    v_cmp_ngt_f32 s[44:45], s41, v3
    v_pk_add_f32 v[64:65], v[64:65], v[80:81]
    v_pk_add_f32 v[66:67], v[66:67], v[82:83]
    v_pk_add_f32 v[68:69], v[68:69], v[84:85]
    v_pk_add_f32 v[70:71], v[70:71], v[86:87]
    v_pk_add_f32 v[72:73], v[72:73], v[88:89]
    v_pk_add_f32 v[74:75], v[74:75], v[90:91]
    v_pk_add_f32 v[24:25], v[64:65], v[66:67]
    v_pk_add_f32 v[26:27], v[68:69], v[70:71]
    v_pk_add_f32 v[28:29], v[72:73], v[74:75]
    v_pk_add_f32 v[24:25], v[24:25], v[26:27]
    v_pk_add_f32 v[24:25], v[24:25], v[28:29]
    s_or_b64 vcc, vcc, s[44:45]
    s_movk_i32 s41, 0x207
    v_add_f32 v24, v24, v25
    v_cmp_class_f32 s[44:45], v24, s41
    s_mov_b32 s41, 0x3d800000
    v_cmp_gt_f32 s[46:47], s41, v1
    s_or_b64 vcc, vcc, s[46:47]
    v_cmp_gt_f32 s[46:47], s41, v3
    s_or_b64 vcc, vcc, s[46:47]
    s_or_b64 vcc, vcc, s[44:45]
    s_cmp_lg_u32 s39, 0
    s_cbranch_scc1 L_store
    s_cbranch_vccnz L_fallback
L_store:
L_end:
    s_endpgm
L_fallback:
    s_barrier
    s_mov_b32 s39, 1
    s_mul_i32 s36, s32, 2560
    v_add_u32 v138, s36, v137
    v_add_u32 v140, s36, v139
    s_sub_u32 s41, 70400, s36
    v_mul_u32_u24 v142, s41, v148
    v_sub_u32 v142, v141, v142
    v_mov_b32 v152, 0xff800000
    v_mov_b32 v153, 0xff800000
    s_mov_b32 s35, s33
    s_mov_b32 s42, 64
L_fb1:
    s_mov_b32 m0, s36
    s_nop 0
    buffer_load_dwordx4 v149, s[24:27], s35 offen lds
    s_mov_b64 exec, 0xffff
    buffer_load_dwordx4 v149, s[24:27], s35 offen offset:1024 lds
    s_mov_b64 exec, -1
    s_waitcnt vmcnt(0)
    s_mov_b32 exec_hi, -1
    ds_read_b64 v[112:113], v140
    s_mov_b32 exec_hi, -1
    ds_read_b64 v[108:109], v138
    ds_read_b64 v[110:111], v138 offset:8
    s_waitcnt lgkmcnt(0)
    v_mfma_f32_32x32x4_2b_bf16 v[0:31], v[112:113], v[104:105], 0 cbsz:1 abid:0
    s_nop 15
    s_nop 1
    v_mfma_f32_32x32x16_bf16 v[0:15], v[108:111], v[96:99], v[0:15]
    v_mfma_f32_32x32x16_bf16 v[16:31], v[108:111], v[100:103], v[16:31]
    s_nop 11
    v_max3_f32 v152, v0, v1, v152
    v_max3_f32 v153, v16, v17, v153
    v_max3_f32 v152, v2, v3, v152
    v_max3_f32 v153, v18, v19, v153
    v_max3_f32 v152, v4, v5, v152
    v_max3_f32 v153, v20, v21, v153
    v_max3_f32 v152, v6, v7, v152
    v_max3_f32 v153, v22, v23, v153
    v_max3_f32 v152, v8, v9, v152
    v_max3_f32 v153, v24, v25, v153
    v_max3_f32 v152, v10, v11, v152
    v_max3_f32 v153, v26, v27, v153
    v_max3_f32 v152, v12, v13, v152
    v_max3_f32 v153, v28, v29, v153
    v_max3_f32 v152, v14, v15, v152
    v_max3_f32 v153, v30, v31, v153
    s_add_u32 s35, s35, 1280
    s_sub_u32 s42, s42, 1
    s_cmp_lg_u32 s42, 0
    s_cbranch_scc1 L_fb1
    v_mov_b32 v154, v152
    v_mov_b32 v155, v153
    s_nop 1
    v_permlane32_swap_b32 v152, v154
    v_permlane32_swap_b32 v153, v155
    s_nop 1
    v_max_f32 v152, v152, v154
    v_max_f32 v153, v153, v155
    v_mov_b32 v64, 0
    v_mov_b32 v65, 0
    v_mov_b32 v66, 0
    v_mov_b32 v67, 0
    v_mov_b32 v68, 0
    v_mov_b32 v69, 0
    v_mov_b32 v70, 0
    v_mov_b32 v71, 0
    v_mov_b32 v72, 0
    v_mov_b32 v73, 0
    v_mov_b32 v74, 0
    v_mov_b32 v75, 0
    v_mov_b32 v76, 0
    v_mov_b32 v77, 0
    v_mov_b32 v78, 0
    v_mov_b32 v79, 0
    v_mov_b32 v80, 0
    v_mov_b32 v81, 0
    v_mov_b32 v82, 0
    v_mov_b32 v83, 0
    v_mov_b32 v84, 0
    v_mov_b32 v85, 0
    v_mov_b32 v86, 0
    v_mov_b32 v87, 0
    v_mov_b32 v88, 0
    v_mov_b32 v89, 0
    v_mov_b32 v90, 0
    v_mov_b32 v91, 0
    v_mov_b32 v92, 0
    v_mov_b32 v93, 0
    v_mov_b32 v94, 0
    v_mov_b32 v95, 0
    s_mov_b32 s35, s33
    s_mov_b32 s42, 64
L_fb2:
    s_mov_b32 m0, s36
    s_nop 0
    buffer_load_dwordx4 v149, s[24:27], s35 offen lds
    s_mov_b64 exec, 0xffff
    buffer_load_dwordx4 v149, s[24:27], s35 offen offset:1024 lds
    s_mov_b64 exec, -1
    s_add_u32 m0, s36, 1280
    s_nop 0
    buffer_load_dwordx4 v149, s[28:31], s35 offen lds
    s_mov_b64 exec, 0xffff
    buffer_load_dwordx4 v149, s[28:31], s35 offen offset:1024 lds
    s_mov_b64 exec, -1
    s_waitcnt vmcnt(0)
    s_mov_b32 exec_hi, -1
    ds_read_b64 v[112:113], v140
    s_mov_b32 exec_hi, -1
    ds_read_b64 v[108:109], v138
    ds_read_b64 v[110:111], v138 offset:8
    ds_read_b64_tr_b16 v[120:121], v142 offset:0
    ds_read_b64_tr_b16 v[122:123], v142 offset:160
    ds_read_b64_tr_b16 v[124:125], v142 offset:640
    ds_read_b64_tr_b16 v[126:127], v142 offset:800
    s_waitcnt lgkmcnt(0)
    v_mfma_f32_32x32x4_2b_bf16 v[0:31], v[112:113], v[104:105], 0 cbsz:1 abid:0
    s_nop 15
    s_nop 1
    v_mfma_f32_32x32x16_bf16 v[0:15], v[108:111], v[96:99], v[0:15]
    v_mfma_f32_32x32x16_bf16 v[16:31], v[108:111], v[100:103], v[16:31]
    s_nop 11
    v_sub_f32 v0, v0, v152
    v_sub_f32 v1, v1, v152
    v_sub_f32 v2, v2, v152
    v_sub_f32 v3, v3, v152
    v_sub_f32 v4, v4, v152
    v_sub_f32 v5, v5, v152
    v_sub_f32 v6, v6, v152
    v_sub_f32 v7, v7, v152
    v_sub_f32 v8, v8, v152
    v_sub_f32 v9, v9, v152
    v_sub_f32 v10, v10, v152
    v_sub_f32 v11, v11, v152
    v_sub_f32 v12, v12, v152
    v_sub_f32 v13, v13, v152
    v_sub_f32 v14, v14, v152
    v_sub_f32 v15, v15, v152
    v_sub_f32 v16, v16, v153
    v_sub_f32 v17, v17, v153
    v_sub_f32 v18, v18, v153
    v_sub_f32 v19, v19, v153
    v_sub_f32 v20, v20, v153
    v_sub_f32 v21, v21, v153
    v_sub_f32 v22, v22, v153
    v_sub_f32 v23, v23, v153
    v_sub_f32 v24, v24, v153
    v_sub_f32 v25, v25, v153
    v_sub_f32 v26, v26, v153
    v_sub_f32 v27, v27, v153
    v_sub_f32 v28, v28, v153
    v_sub_f32 v29, v29, v153
    v_sub_f32 v30, v30, v153
    v_sub_f32 v31, v31, v153
    v_exp_f32 v0, v0
    v_exp_f32 v1, v1
    v_exp_f32 v2, v2
    v_exp_f32 v3, v3
    v_exp_f32 v4, v4
    v_exp_f32 v5, v5
    v_exp_f32 v6, v6
    v_exp_f32 v7, v7
    v_exp_f32 v8, v8
    v_exp_f32 v9, v9
    v_exp_f32 v10, v10
    v_exp_f32 v11, v11
    v_exp_f32 v12, v12
    v_exp_f32 v13, v13
    v_exp_f32 v14, v14
    v_exp_f32 v15, v15
    v_exp_f32 v16, v16
    v_exp_f32 v17, v17
    v_exp_f32 v18, v18
    v_exp_f32 v19, v19
    v_exp_f32 v20, v20
    v_exp_f32 v21, v21
    v_exp_f32 v22, v22
    v_exp_f32 v23, v23
    v_exp_f32 v24, v24
    v_exp_f32 v25, v25
    v_exp_f32 v26, v26
    v_exp_f32 v27, v27
    v_exp_f32 v28, v28
    v_exp_f32 v29, v29
    v_exp_f32 v30, v30
    v_exp_f32 v31, v31
    s_nop 1
    v_smfmac_f32_32x32x32_bf16 v[64:79], v[120:123], v[0:7], v136
    v_smfmac_f32_32x32x32_bf16 v[64:79], v[124:127], v[8:15], v136
    v_smfmac_f32_32x32x32_bf16 v[80:95], v[120:123], v[16:23], v136
    v_smfmac_f32_32x32x32_bf16 v[80:95], v[124:127], v[24:31], v136
    s_add_u32 s35, s35, 1280
    s_sub_u32 s42, s42, 1
    s_cmp_lg_u32 s42, 0
    s_cbranch_scc1 L_fb2
    s_nop 11
    s_mul_i32 s42, s32, 2560
    s_add_u32 s42, s42, 20480
    v_add_u32 v8, s42, v162
    v_add_u32 v10, s42, v149
    v_mov_b32 v0, v72
    v_mov_b32 v1, v72
    s_nop 1
    v_permlane32_swap_b32 v0, v1
    s_nop 0
    v_rcp_f32 v4, v1
    s_nop 0
    v_pk_mul_f32 v[64:65], v[64:65], v[4:5] op_sel_hi:[1,0]
    v_pk_mul_f32 v[66:67], v[66:67], v[4:5] op_sel_hi:[1,0]
    v_pk_mul_f32 v[68:69], v[68:69], v[4:5] op_sel_hi:[1,0]
    v_pk_mul_f32 v[70:71], v[70:71], v[4:5] op_sel_hi:[1,0]
    v_pk_mul_f32 v[72:73], v[72:73], v[4:5] op_sel_hi:[1,0]
    v_pk_mul_f32 v[74:75], v[74:75], v[4:5] op_sel_hi:[1,0]
    v_cvt_pk_bf16_f32 v16, v64, v65
    v_cvt_pk_bf16_f32 v17, v66, v67
    v_cvt_pk_bf16_f32 v18, v68, v69
    v_cvt_pk_bf16_f32 v19, v70, v71
    v_cvt_pk_bf16_f32 v20, v72, v73
    v_cvt_pk_bf16_f32 v21, v74, v75
    ds_write_b64 v8, v[16:17] offset:0
    ds_write_b64 v8, v[18:19] offset:16
    s_mov_b32 exec_hi, 0
    ds_write_b64 v8, v[20:21] offset:32
    s_mov_b32 exec_hi, -1
    ds_read_b128 v[12:15], v10
L_last:
    s_branch L_norm
.section .rodata,"a"
.p2align 6
.amdhsa_kernel standalone__fused_io_aware_attn__prompt_kernel
  .amdhsa_next_free_vgpr 224
  .amdhsa_next_free_sgpr 50
  .amdhsa_accum_offset 224
  .amdhsa_group_segment_fixed_size 0
  .amdhsa_kernarg_size 48
  .amdhsa_user_sgpr_count 2
  .amdhsa_user_sgpr_kernarg_segment_ptr 1
  .amdhsa_system_sgpr_workgroup_id_x 1
.end_amdhsa_kernel
```
